```python
import torch

def _softmax(x, axis=-1):
    return torch.softmax(x, dim=axis)

def _gelu(x):
    return torch.nn.functional.gelu(x, approximate='tanh')

def _silu(x):
    return torch.nn.functional.silu(x)

def _sigmoid(x):
    return torch.sigmoid(x)

def _layernorm(x, axis=-1, eps=1e-05):
    m = x.mean(dim=axis, keepdim=True)
    v = x.var(dim=axis, keepdim=True, unbiased=False)
    return (x - m) / torch.sqrt(v + eps)

def _scatter_add(tgt, idx, src, axis=0):
    return tgt.clone().index_add_(axis, idx, src)

def _segment_sum(src, seg, n):
    out = torch.zeros((n,) + src.shape[1:], dtype=src.dtype)
    return out.index_add_(0, seg, src)

def _pad(x, pw):
    flat = tuple((v for pair in reversed(pw) for v in pair))
    return torch.nn.functional.pad(x, flat)
kernel_name = 'adaLN_cond__ssm_conv_s4__dense_activation_squared_relu__prompt'

def setup_inputs():

    _w = lambda a: (lambda t: t.to(torch.bfloat16) if t.is_floating_point() else t)(torch.as_tensor(a))

    def _A_setup():
        B, L, D, N = (1, 2048, 512, 128)
        A_re = -(lambda _x: torch.exp(torch.as_tensor(_x)))((lambda *s: torch.randn(*s, dtype=torch.bfloat16) * 3.2)(D, N))
        A_im = torch.pi * (lambda *s: torch.randn(*s, dtype=torch.bfloat16) * 0.1)(D, N)
        B_re = (lambda *s: torch.randn(*s, dtype=torch.bfloat16) * 0.2)(D, N)
        B_im = (lambda *s: torch.randn(*s, dtype=torch.bfloat16) * 0.2)(D, N)
        C_re = (lambda *s: torch.randn(*s, dtype=torch.bfloat16) * 0.2)(D, N)
        C_im = (lambda *s: torch.randn(*s, dtype=torch.bfloat16) * 0.2)(D, N)
        log_dt = (lambda *s: torch.randn(*s, dtype=torch.bfloat16) * 0.1)(D) * 0.5 - 4.0
        Dskip = (lambda *s: torch.randn(*s, dtype=torch.bfloat16) * 0.2)(D)
        return {'u': _w((lambda *s: torch.randn(*s, dtype=torch.bfloat16) * 0.05)(B, L, D)), 'A_re': _w(A_re), 'A_im': _w(A_im), 'B_re': _w(B_re), 'B_im': _w(B_im), 'C_re': _w(C_re), 'C_im': _w(C_im), 'log_dt': _w(log_dt), 'Dskip': _w(Dskip)}
    _A_in = _A_setup()

    def _B_setup():
        B, S, D, F = (1, 2048, 512, 1376)
        return {'x': _w((lambda *s: torch.randn(*s, dtype=torch.bfloat16) * 0.05)(B, S, D)), 'w1': _w((lambda *s: torch.randn(*s, dtype=torch.bfloat16) * 0.05)(D, F)), 'b1': _w((lambda *s: torch.randn(*s, dtype=torch.bfloat16) * 0.4)(F)), 'w2': _w((lambda *s: torch.randn(*s, dtype=torch.bfloat16) * 0.05)(F, D)), 'b2': _w((lambda *s: torch.randn(*s, dtype=torch.bfloat16) * 3.2)(D))}
    _B_in = _B_setup()
    return {'A_u': _A_in['u'], 'A_A_re': _A_in['A_re'], 'A_A_im': _A_in['A_im'], 'A_B_re': _A_in['B_re'], 'A_B_im': _A_in['B_im'], 'A_C_re': _A_in['C_re'], 'A_C_im': _A_in['C_im'], 'A_log_dt': _A_in['log_dt'], 'A_Dskip': _A_in['Dskip'], 'B_x': _B_in['x'], 'B_w1': _B_in['w1'], 'B_b1': _B_in['b1'], 'B_w2': _B_in['w2'], 'B_b2': _B_in['b2'], 'c': _w((lambda *s: torch.randn(*s, dtype=torch.bfloat16) * 0.1)(1, 512) * 8.0), 'w_mod': _w((lambda *s: torch.randn(*s, dtype=torch.bfloat16) * 0.1)(512, 6 * 512) * 512 ** (-0.5) * 8.0)}

def reference(A_u, A_A_re, A_A_im, A_B_re, A_B_im, A_C_re, A_C_im, A_log_dt, A_Dskip, B_x, B_w1, B_b1, B_w2, B_b2, c, w_mod):

    def _A_ref(u, A_re, A_im, B_re, B_im, C_re, C_im, log_dt, Dskip):
        Bsz, L, D = u.shape
        dt = torch.exp(log_dt)[:, None]
        A = A_re + 1j * A_im
        Bc = B_re + 1j * B_im
        Cc = C_re + 1j * C_im
        logdA = dt * A
        dB = dt * Bc
        l = (lambda x, dt: x.to(dt))(torch.arange(L), A_re.dtype)
        P = torch.exp(logdA[:, :, None] * l[None, None, :])
        K = torch.einsum('dn,dnl,dn->dl', Cc, P, dB).real
        L2 = 2 * L
        Kp = _pad(K, ((0, 0), (0, L)))
        up = (lambda x, *d: x.permute(*d))(u, 0, 2, 1)
        up = _pad(up, ((0, 0), (0, 0), (0, L)))
        Kf = (lambda x, axes=(-2, -1): torch.fft.rfft2(x.float(), dim=axes))(Kp[:, None, :], axes=(-2, -1))
        Uf = (lambda x, axes=(-2, -1): torch.fft.rfft2(x.float(), dim=axes))(up[:, :, None, :], axes=(-2, -1))
        Yf = Uf * Kf[None, :, :, :]
        y = (lambda x, s, axes=(-2, -1): torch.fft.irfft2(x, s=s, dim=axes).to(torch.bfloat16))(Yf, (1, L2), axes=(-2, -1))[:, :, 0, :L]
        y = (lambda x, *d: x.permute(*d))(y, 0, 2, 1) + u * Dskip[None, None, :]
        return y

    def _B_ref(x, w1, b1, w2, b2):
        h = torch.einsum('bsd,df->bsf', x, w1) + b1
        zero = torch.zeros_like(h)
        r = torch.where(h > zero, h, zero)
        h = r * r
        out = torch.einsum('bsf,fd->bsd', h, w2) + b2
        return out
    x = A_u
    mod = (_silu(c) @ w_mod).reshape(c.shape[0], 6, 1, -1)
    sa, ca, ga, sb, cb, gb = (mod[:, 0].clone(), mod[:, 1].clone(), mod[:, 2].clone(), mod[:, 3].clone(), mod[:, 4].clone(), mod[:, 5].clone())
    h = _layernorm(x, axis=-1) * (1 + ca) + sa
    x = x + ga * _A_ref(h, A_A_re, A_A_im, A_B_re, A_B_im, A_C_re, A_C_im, A_log_dt, A_Dskip)
    h = _layernorm(x, axis=-1) * (1 + cb) + sb
    x = x + gb * _B_ref(h, B_w1, B_b1, B_w2, B_b2)
    return x
```

```asm
; @launch grid=(256,1,1) block=(512,1,1) lds=156176
.amdgcn_target "amdgcn-amd-amdhsa--gfx950"
.text
.globl adaLN_cond__ssm_conv_s4__dense_activation_squared_relu__prompt_kernel
.p2align 8
.type adaLN_cond__ssm_conv_s4__dense_activation_squared_relu__prompt_kernel,@function
adaLN_cond__ssm_conv_s4__dense_activation_squared_relu__prompt_kernel:
    s_cmp_lt_u32 s2, 8
    s_cbranch_scc0 pf_skip_0
    v_cmp_gt_u32 vcc, 64, v0
    s_and_saveexec_b64 s[64:65], vcc
    s_cbranch_execz pf_rest_0
    s_getpc_b64 s[66:67]
pf_here_0:
    s_add_u32 s66, s66, pf_here_0-pf_here_0
    s_addc_u32 s67, s67, 0
    v_lshlrev_b32 v126, 6, v0
    s_mov_b32 s68, 0
    s_mov_b32 s69, text_end-pf_here_0-4
pf_loop_0:
    v_min_u32 v126, s69, v126
    global_load_dword v127, v126, s[66:67]
    v_add_u32 v126, 4096, v126
    s_add_u32 s68, s68, 4096
    s_cmp_lt_u32 s68, text_end-pf_here_0
    s_cbranch_scc1 pf_loop_0
pf_rest_0:
    s_mov_b64 exec, s[64:65]
pf_skip_0:
    s_cmp_ge_u32 s2, 256
    s_cbranch_scc1 ab_other
    v_lshrrev_b32 v3, 6, v0
    v_and_b32 v1, 63, v0
    s_and_b32 s6, s2, 7
    s_lshr_b32 s7, s2, 3
    v_readfirstlane_b32 s26, v3
    v_lshlrev_b32 v4, 2, v0
    v_add_u32 v4, 80016, v4
    v_mov_b32 v5, 0
    v_cmp_gt_u32 vcc, 8, v0
    s_and_saveexec_b64 s[54:55], vcc
    ds_write_b32 v4, v5
    s_mov_b64 exec, s[54:55]
    s_lshl_b32 s29, s6, 6
    s_lshl_b32 s30, s7, 1
    s_add_u32 s29, s29, s30
    s_waitcnt lgkmcnt(0)
    s_barrier
    s_cmp_lt_u32 s26, 4
    s_cbranch_scc1 kwaves
pwaves:
    s_load_dwordx2 s[4:5], s[0:1], 0
    s_load_dwordx4 s[44:47], s[0:1], 112
    s_load_dwordx4 s[20:23], s[0:1], 136
    s_load_dwordx4 s[8:11], s[0:1], 80
    s_load_dwordx2 s[48:49], s[0:1], 96
    s_setprio 1
    v_subrev_u32 v0, 256, v0
    s_sub_u32 s26, s26, 4
    v_lshrrev_b32 v3, 6, v0
    v_lshrrev_b32 v8, 4, v1
    v_and_b32 v9, 15, v1
    v_lshlrev_b32 v4, 10, v8
    v_lshl_add_u32 v4, v9, 4, v4
    v_lshl_add_u32 v4, v3, 8, v4
    s_lshl_b32 s31, s2, 13
    v_add_u32 v4, s31, v4
    v_add_u32 v44, 4096, v4
    s_min_u32 s32, s7, 23
    s_mul_i32 s33, s6, 24
    s_add_u32 s33, s33, s32
    v_lshrrev_b32 v5, 1, v0
    v_and_b32 v6, 1, v0
    v_mul_u32_u24 v7, 24576, v5
    v_lshl_add_u32 v7, v6, 4, v7
    s_lshl_b32 s34, s33, 5
    v_add_u32 v7, s34, v7
    v_lshlrev_b32 v2, 3, v5
    s_and_b32 s34, s2, 3
    s_lshl_b32 s34, s34, 6
    s_add_u32 s34, s34, 4
    v_mov_b32 v94, s34
    v_mov_b32 v95, 0
    s_and_b32 s34, s2, 7
    s_lshl_b32 s34, s34, 11
    s_add_u32 s34, s34, 188416
    v_and_b32 v92, 15, v1
    v_lshl_add_u32 v92, v92, 7, s34
    v_mov_b32 v93, 1
    s_waitcnt lgkmcnt(0)
    global_load_dwordx4 v[8:11], v4, s[4:5]
    global_load_dwordx4 v[12:15], v44, s[4:5]
    global_load_dwordx2 v[16:17], v2, s[44:45]
    global_load_dwordx4 v[20:23], v7, s[46:47]
    v_add_u32 v7, 6144, v7
    global_load_dwordx4 v[24:27], v7, s[46:47]
    v_add_u32 v7, 6144, v7
    global_load_dwordx4 v[28:31], v7, s[46:47]
    v_add_u32 v7, 6144, v7
    global_load_dwordx4 v[32:35], v7, s[46:47]
    v_mov_b32 v38, 0x3f803f80
    v_lshrrev_b32 v40, 4, v1
    v_mul_u32_u24 v39, 320, v40
    v_and_b32 v41, 15, v1
    v_lshl_add_u32 v39, v41, 4, v39
    s_mul_i32 s34, s26, 2560
    s_add_u32 s34, s34, 62016
    v_add_u32 v39, s34, v39
    v_lshrrev_b32 v47, 2, v41
    v_mul_u32_u24 v47, 320, v47
    v_and_b32 v46, 3, v41
    v_lshl_add_u32 v47, v46, 3, v47
    v_lshl_add_u32 v47, v40, 5, v47
    v_add_u32 v47, s34, v47
    v_lshl_add_u32 v46, v3, 7, v1
    v_lshlrev_b32 v46, 4, v46
    s_mul_i32 s34, s2, 8192
    s_add_u32 s34, s34, 1048576
    v_add_u32 v46, s34, v46
    v_lshlrev_b32 v45, 3, v40
    s_lshl_b32 s34, s26, 6
    s_add_u32 s34, s34, 79744
    v_add_u32 v45, s34, v45
    s_waitcnt vmcnt(6)
    ds_write_b128 v39, v[8:11] offset:0
    v_dot2_f32_bf16 v72, v8, v38, 0
    v_dot2_f32_bf16 v73, v8, v8, 0
    v_dot2_f32_bf16 v72, v9, v38, v72
    v_dot2_f32_bf16 v73, v9, v9, v73
    v_dot2_f32_bf16 v72, v10, v38, v72
    v_dot2_f32_bf16 v73, v10, v10, v73
    v_dot2_f32_bf16 v72, v11, v38, v72
    v_dot2_f32_bf16 v73, v11, v11, v73
    s_waitcnt vmcnt(5)
    ds_write_b128 v39, v[12:15] offset:1280
    v_dot2_f32_bf16 v74, v12, v38, 0
    v_dot2_f32_bf16 v75, v12, v12, 0
    v_dot2_f32_bf16 v74, v13, v38, v74
    v_dot2_f32_bf16 v75, v13, v13, v75
    v_dot2_f32_bf16 v74, v14, v38, v74
    v_dot2_f32_bf16 v75, v14, v14, v75
    v_dot2_f32_bf16 v74, v15, v38, v74
    v_dot2_f32_bf16 v75, v15, v15, v75
    s_waitcnt lgkmcnt(0)
    ds_read_b64_tr_b16 v[48:49], v47
    ds_read_b64_tr_b16 v[50:51], v47 offset:1280
    ds_read_b64_tr_b16 v[52:53], v47 offset:128
    ds_read_b64_tr_b16 v[54:55], v47 offset:1408
    s_waitcnt vmcnt(4)
    v_lshlrev_b32 v56, 16, v16
    v_and_b32 v57, 0xffff0000, v16
    v_lshlrev_b32 v58, 16, v17
    v_and_b32 v59, 0xffff0000, v17
    v_mul_f32 v60, 0xbfb8aa3b, v56
    v_mul_f32 v61, 0xbfb8aa3b, v57
    v_mul_f32 v62, 0xbfb8aa3b, v58
    v_mul_f32 v63, 0xbfb8aa3b, v59
    v_exp_f32 v60, v60
    v_exp_f32 v61, v61
    v_exp_f32 v62, v62
    v_exp_f32 v63, v63
    v_add_f32_dpp v72, v72, v72 row_shr:1 row_mask:0xf bank_mask:0xf
    v_add_f32_dpp v73, v73, v73 row_shr:1 row_mask:0xf bank_mask:0xf
    v_add_f32_dpp v74, v74, v74 row_shr:1 row_mask:0xf bank_mask:0xf
    v_add_f32_dpp v75, v75, v75 row_shr:1 row_mask:0xf bank_mask:0xf
    v_add_f32 v60, 1.0, v60
    v_add_f32 v61, 1.0, v61
    v_add_f32 v62, 1.0, v62
    v_add_f32 v63, 1.0, v63
    v_add_f32_dpp v72, v72, v72 row_shr:2 row_mask:0xf bank_mask:0xf
    v_add_f32_dpp v73, v73, v73 row_shr:2 row_mask:0xf bank_mask:0xf
    v_add_f32_dpp v74, v74, v74 row_shr:2 row_mask:0xf bank_mask:0xf
    v_add_f32_dpp v75, v75, v75 row_shr:2 row_mask:0xf bank_mask:0xf
    v_rcp_f32 v60, v60
    v_rcp_f32 v61, v61
    v_rcp_f32 v62, v62
    v_rcp_f32 v63, v63
    v_add_f32_dpp v72, v72, v72 row_shr:4 row_mask:0xf bank_mask:0xf
    v_add_f32_dpp v73, v73, v73 row_shr:4 row_mask:0xf bank_mask:0xf
    v_add_f32_dpp v74, v74, v74 row_shr:4 row_mask:0xf bank_mask:0xf
    v_add_f32_dpp v75, v75, v75 row_shr:4 row_mask:0xf bank_mask:0xf
    v_mul_f32 v56, v56, v60
    v_mul_f32 v57, v57, v61
    v_mul_f32 v58, v58, v62
    v_mul_f32 v59, v59, v63
    v_add_f32_dpp v72, v72, v72 row_shr:8 row_mask:0xf bank_mask:0xf
    v_add_f32_dpp v73, v73, v73 row_shr:8 row_mask:0xf bank_mask:0xf
    v_add_f32_dpp v74, v74, v74 row_shr:8 row_mask:0xf bank_mask:0xf
    v_add_f32_dpp v75, v75, v75 row_shr:8 row_mask:0xf bank_mask:0xf
    v_cvt_pk_bf16_f32 v60, v56, 0
    v_cvt_pk_bf16_f32 v76, 0, v56
    v_cvt_pk_bf16_f32 v61, v57, 0
    v_cvt_pk_bf16_f32 v77, 0, v57
    v_cvt_pk_bf16_f32 v62, v58, 0
    v_cvt_pk_bf16_f32 v78, 0, v58
    v_cvt_pk_bf16_f32 v63, v59, 0
    v_cvt_pk_bf16_f32 v79, 0, v59
    s_waitcnt lgkmcnt(0)
    global_store_dwordx4 v46, v[48:51], s[22:23] sc1
    global_store_dwordx4 v46, v[52:55], s[22:23] offset:1024 sc1
    v_cmp_eq_u32 vcc, 15, v41
    s_and_saveexec_b64 s[54:55], vcc
    ds_write_b64 v45, v[72:73]
    ds_write_b64 v45, v[74:75] offset:32
    s_mov_b64 exec, s[54:55]
    s_waitcnt vmcnt(5)
    v_dot2_f32_bf16 v64, v20, v60, 0
    v_dot2_f32_bf16 v65, v20, v76, 0
    v_dot2_f32_bf16 v66, v21, v60, 0
    v_dot2_f32_bf16 v67, v21, v76, 0
    v_dot2_f32_bf16 v68, v22, v60, 0
    v_dot2_f32_bf16 v69, v22, v76, 0
    v_dot2_f32_bf16 v70, v23, v60, 0
    v_dot2_f32_bf16 v71, v23, v76, 0
    s_waitcnt vmcnt(4)
    v_dot2_f32_bf16 v64, v24, v61, v64
    v_dot2_f32_bf16 v65, v24, v77, v65
    v_dot2_f32_bf16 v66, v25, v61, v66
    v_dot2_f32_bf16 v67, v25, v77, v67
    v_dot2_f32_bf16 v68, v26, v61, v68
    v_dot2_f32_bf16 v69, v26, v77, v69
    v_dot2_f32_bf16 v70, v27, v61, v70
    v_dot2_f32_bf16 v71, v27, v77, v71
    s_waitcnt vmcnt(3)
    v_dot2_f32_bf16 v64, v28, v62, v64
    v_dot2_f32_bf16 v65, v28, v78, v65
    v_dot2_f32_bf16 v66, v29, v62, v66
    v_dot2_f32_bf16 v67, v29, v78, v67
    v_dot2_f32_bf16 v68, v30, v62, v68
    v_dot2_f32_bf16 v69, v30, v78, v69
    v_dot2_f32_bf16 v70, v31, v62, v70
    v_dot2_f32_bf16 v71, v31, v78, v71
    s_waitcnt vmcnt(2)
    v_dot2_f32_bf16 v64, v32, v63, v64
    v_dot2_f32_bf16 v65, v32, v79, v65
    v_dot2_f32_bf16 v66, v33, v63, v66
    v_dot2_f32_bf16 v67, v33, v79, v67
    v_dot2_f32_bf16 v68, v34, v63, v68
    v_dot2_f32_bf16 v69, v34, v79, v69
    v_dot2_f32_bf16 v70, v35, v63, v70
    v_dot2_f32_bf16 v71, v35, v79, v71
    s_nop 2
    v_add_f32_dpp v64, v64, v64 row_shr:2 row_mask:0xf bank_mask:0xf
    v_add_f32_dpp v65, v65, v65 row_shr:2 row_mask:0xf bank_mask:0xf
    v_add_f32_dpp v66, v66, v66 row_shr:2 row_mask:0xf bank_mask:0xf
    v_add_f32_dpp v67, v67, v67 row_shr:2 row_mask:0xf bank_mask:0xf
    v_add_f32_dpp v68, v68, v68 row_shr:2 row_mask:0xf bank_mask:0xf
    v_add_f32_dpp v69, v69, v69 row_shr:2 row_mask:0xf bank_mask:0xf
    v_add_f32_dpp v70, v70, v70 row_shr:2 row_mask:0xf bank_mask:0xf
    v_add_f32_dpp v71, v71, v71 row_shr:2 row_mask:0xf bank_mask:0xf
    v_add_f32_dpp v64, v64, v64 row_shr:4 row_mask:0xf bank_mask:0xf
    v_add_f32_dpp v65, v65, v65 row_shr:4 row_mask:0xf bank_mask:0xf
    v_add_f32_dpp v66, v66, v66 row_shr:4 row_mask:0xf bank_mask:0xf
    v_add_f32_dpp v67, v67, v67 row_shr:4 row_mask:0xf bank_mask:0xf
    v_add_f32_dpp v68, v68, v68 row_shr:4 row_mask:0xf bank_mask:0xf
    v_add_f32_dpp v69, v69, v69 row_shr:4 row_mask:0xf bank_mask:0xf
    v_add_f32_dpp v70, v70, v70 row_shr:4 row_mask:0xf bank_mask:0xf
    v_add_f32_dpp v71, v71, v71 row_shr:4 row_mask:0xf bank_mask:0xf
    v_add_f32_dpp v64, v64, v64 row_shr:8 row_mask:0xf bank_mask:0xf
    v_add_f32_dpp v65, v65, v65 row_shr:8 row_mask:0xf bank_mask:0xf
    v_add_f32_dpp v66, v66, v66 row_shr:8 row_mask:0xf bank_mask:0xf
    v_add_f32_dpp v67, v67, v67 row_shr:8 row_mask:0xf bank_mask:0xf
    v_add_f32_dpp v68, v68, v68 row_shr:8 row_mask:0xf bank_mask:0xf
    v_add_f32_dpp v69, v69, v69 row_shr:8 row_mask:0xf bank_mask:0xf
    v_add_f32_dpp v70, v70, v70 row_shr:8 row_mask:0xf bank_mask:0xf
    v_add_f32_dpp v71, v71, v71 row_shr:8 row_mask:0xf bank_mask:0xf
    v_lshrrev_b32 v4, 4, v0
    v_mul_u32_u24 v4, 80, v4
    v_lshl_add_u32 v4, v6, 5, v4
    v_add_u32 v4, 78464, v4
    v_and_b32 v5, 15, v0
    v_cmp_lt_u32 vcc, 13, v5
    v_lshlrev_b32 v5, 2, v5
    v_add_u32 v5, 78464, v5
    s_and_saveexec_b64 s[54:55], vcc
    ds_write_b128 v4, v[64:67]
    ds_write_b128 v4, v[68:71] offset:16
    s_mov_b64 exec, s[54:55]
    s_waitcnt lgkmcnt(0)
    s_cmp_eq_u32 s26, 0
    s_cbranch_scc0 p_nogo
    s_mov_b64 exec, 1
    global_atomic_add v96, v94, v95, s[20:21] sc0 sc1
    s_mov_b64 exec, -1
p_nogo:
    v_mov_b32 v36, 80016
    v_mov_b32 v37, 1
    s_mov_b64 exec, 1
    ds_add_u32 v36, v37
    s_mov_b64 exec, -1
    v_mov_b32 v36, 80016
lw_p1:
    ds_read_b32 v37, v36
    s_waitcnt lgkmcnt(0)
    v_readfirstlane_b32 s62, v37
    s_cmp_ge_u32 s62, 4
    s_cbranch_scc1 lw_p1_done
    s_sleep 1
    s_branch lw_p1
lw_p1_done:
    ds_read_b32 v20, v5 offset:0
    ds_read_b32 v21, v5 offset:80
    ds_read_b32 v22, v5 offset:160
    ds_read_b32 v23, v5 offset:240
    ds_read_b32 v24, v5 offset:320
    ds_read_b32 v25, v5 offset:400
    ds_read_b32 v26, v5 offset:480
    ds_read_b32 v27, v5 offset:560
    ds_read_b32 v28, v5 offset:640
    ds_read_b32 v29, v5 offset:720
    ds_read_b32 v30, v5 offset:800
    ds_read_b32 v31, v5 offset:880
    ds_read_b32 v32, v5 offset:960
    ds_read_b32 v33, v5 offset:1040
    ds_read_b32 v34, v5 offset:1120
    ds_read_b32 v35, v5 offset:1200
    v_and_b32 v58, 7, v0
    v_lshlrev_b32 v59, 3, v58
    v_add_u32 v59, 79744, v59
    ds_read_b64 v[48:49], v59
    ds_read_b64 v[50:51], v59 offset:64
    ds_read_b64 v[52:53], v59 offset:128
    ds_read_b64 v[54:55], v59 offset:192
    v_lshlrev_b32 v58, 2, v58
    s_lshl_b32 s34, s2, 5
    s_add_u32 s34, s34, 16384
    v_add_u32 v58, s34, v58
    s_waitcnt lgkmcnt(0)
    v_add_f32 v48, v48, v50
    v_add_f32 v49, v49, v51
    v_add_f32 v52, v52, v54
    v_add_f32 v53, v53, v55
    v_add_f32 v56, v48, v52
    v_add_f32 v57, v49, v53
    v_mul_f32 v56, 0x3b000000, v56
    v_mul_f32 v57, 0x3b000000, v57
    v_fma_f32 v57, -v56, v56, v57
    v_max_f32 v57, 0, v57
    v_add_f32 v57, 0x3727c5ac, v57
    v_rsq_f32 v57, v57
    v_cmp_gt_u32 vcc, 8, v0
    v_mul_f32 v56, -v56, v57
    v_cvt_pk_bf16_f32 v56, v57, v56
    s_and_saveexec_b64 s[54:55], vcc
    s_cbranch_execz p_nostat
    global_store_dword v58, v56, s[22:23] sc1
p_nostat:
    s_mov_b64 exec, s[54:55]
    v_add_f32 v20, v20, v21
    v_add_f32 v22, v22, v23
    v_add_f32 v24, v24, v25
    v_add_f32 v26, v26, v27
    v_add_f32 v28, v28, v29
    v_add_f32 v30, v30, v31
    v_add_f32 v32, v32, v33
    v_add_f32 v34, v34, v35
    v_add_f32 v20, v20, v22
    v_add_f32 v24, v24, v26
    v_add_f32 v28, v28, v30
    v_add_f32 v32, v32, v34
    v_add_f32 v20, v20, v24
    v_add_f32 v28, v28, v32
    v_add_f32 v20, v20, v28
    v_cvt_pk_bf16_f32 v20, v20, v20
    v_lshlrev_b32 v20, 16, v20
    s_lshl_b32 s34, s33, 7
    s_add_u32 s34, s34, 65536
    v_lshlrev_b32 v4, 2, v0
    v_add_u32 v4, s34, v4
    s_cmp_lt_u32 s7, 24
    s_cselect_b32 s34, 16, 0
    v_cmp_gt_u32 vcc, s34, v0
    s_and_saveexec_b64 s[54:55], vcc
    s_cbranch_execz p_nomod
    global_store_dword v4, v20, s[22:23] sc1
p_nomod:
    s_mov_b64 exec, s[54:55]
    s_cmp_eq_u32 s2, 0
    s_cbranch_scc0 p_nozero
    s_cmp_eq_u32 s26, 1
    s_cbranch_scc0 p_nozero
    v_lshlrev_b32 v60, 7, v1
    v_add_u32 v60, 163840, v60
    v_mov_b32 v62, 0
    v_mov_b32 v63, 0
    v_mov_b32 v64, 0
    v_mov_b32 v65, 0
    global_store_dwordx4 v60, v[62:65], s[22:23] sc1
    v_add_u32 v60, 8192, v60
    global_store_dwordx4 v60, v[62:65], s[22:23] sc1
    v_add_u32 v60, 8192, v60
    global_store_dwordx4 v60, v[62:65], s[22:23] sc1
p_nozero:
    s_waitcnt vmcnt(0)
    v_mov_b32 v36, 80020
    v_mov_b32 v37, 1
    s_mov_b64 exec, 1
    ds_add_u32 v36, v37
    s_mov_b64 exec, -1
    s_cmp_eq_u32 s26, 0
    s_cbranch_scc0 p_noentry
    v_mov_b32 v36, 80020
lw_p2:
    ds_read_b32 v37, v36
    s_waitcnt lgkmcnt(0)
    v_readfirstlane_b32 s62, v37
    s_cmp_ge_u32 s62, 4
    s_cbranch_scc1 lw_p2_done
    s_sleep 1
    s_branch lw_p2
lw_p2_done:
    s_mov_b32 s60, 0
p_flag:
    v_readfirstlane_b32 s36, v96
    s_nop 0
    s_cmp_lg_u32 s36, 0
    s_cbranch_scc1 p_flag_ok
    s_mov_b64 exec, 1
    global_atomic_add v96, v94, v95, s[20:21] sc0 sc1
    s_waitcnt vmcnt(0)
    s_mov_b64 exec, -1
    s_add_u32 s60, s60, 1
    s_cmp_lt_u32 s60, 131072
    s_cbranch_scc1 p_flag
p_flag_ok:
    s_mov_b64 exec, 0xffff
    global_atomic_add v92, v93, s[22:23] sc1
    s_mov_b64 exec, -1
    v_mov_b32 v36, 80040
    v_mov_b32 v37, 1
    s_mov_b64 exec, 1
    ds_add_u32 v36, v37
    s_mov_b64 exec, -1
p_noentry:
    v_add_u32 v11, 256, v0
    v_lshrrev_b32 v12, 1, v11
    v_and_b32 v10, 1, v11
    v_lshlrev_b32 v4, 13, v12
    v_lshl_add_u32 v4, v10, 4, v4
    s_lshl_b32 s38, s29, 4
    s_add_u32 s38, s38, 1048576
    v_add_u32 v4, s38, v4
    v_lshlrev_b32 v5, 5, v12
    v_add_u32 v5, 16384, v5
    s_lshr_b32 s38, s29, 4
    s_lshl_b32 s38, s38, 7
    s_and_b32 s39, s29, 15
    s_lshl_b32 s39, s39, 2
    s_add_u32 s38, s38, s39
    s_add_u32 s38, s38, 65536
    v_lshl_add_u32 v6, v10, 2, s38
    v_mul_u32_u24 v7, 4608, v10
    v_lshl_add_u32 v7, v12, 4, v7
    v_add_u32 v7, 33792, v7
    v_lshlrev_b32 v8, 12, v10
    v_lshl_add_u32 v8, v12, 4, v8
    v_add_u32 v8, 42496, v8
    v_lshlrev_b32 v9, 2, v10
    v_add_u32 v9, 78464, v9
    v_add_u32 v13, 4096, v6
    v_add_u32 v14, 4096, v13
    s_cmp_lt_u32 s2, 86
    s_cbranch_scc0 p_now1
    v_lshrrev_b32 v18, 1, v0
    v_and_b32 v19, 1, v0
    v_mul_u32_u24 v16, 11008, v18
    v_lshl_add_u32 v16, v19, 4, v16
    s_lshl_b32 s12, s2, 5
    v_add_u32 v16, s12, v16
    global_load_dwordx4 v[100:103], v16, s[8:9]
    v_add_u32 v16, 2752, v16
    global_load_dwordx4 v[104:107], v16, s[8:9]
    v_add_u32 v16, 2752, v16
    global_load_dwordx4 v[108:111], v16, s[8:9]
    v_add_u32 v16, 2752, v16
    global_load_dwordx4 v[112:115], v16, s[8:9]
    v_and_b32 v17, 15, v0
    v_lshlrev_b32 v17, 1, v17
    v_add_u32 v17, s12, v17
    global_load_ushort v56, v17, s[10:11]
    v_mov_b32 v57, 0x3f803f80
    v_lshrrev_b32 v58, 2, v18
    v_lshlrev_b32 v58, 9, v58
    v_bfe_u32 v59, v18, 1, 1
    v_lshl_add_u32 v58, v59, 8, v58
    v_lshl_add_u32 v58, v19, 7, v58
    v_and_b32 v59, 1, v18
    v_lshl_add_u32 v58, v59, 3, v58
    v_add_u32 v58, 80128, v58
    s_waitcnt vmcnt(1)
    v_lshlrev_b32 v24, 16, v100
    v_and_b32 v25, 0xffff0000, v100
    v_lshlrev_b32 v26, 16, v101
    v_and_b32 v27, 0xffff0000, v101
    v_lshlrev_b32 v28, 16, v102
    v_and_b32 v29, 0xffff0000, v102
    v_lshlrev_b32 v30, 16, v103
    v_and_b32 v31, 0xffff0000, v103
    v_lshlrev_b32 v32, 16, v104
    v_and_b32 v33, 0xffff0000, v104
    v_lshlrev_b32 v34, 16, v105
    v_and_b32 v35, 0xffff0000, v105
    v_lshlrev_b32 v36, 16, v106
    v_and_b32 v37, 0xffff0000, v106
    v_lshlrev_b32 v38, 16, v107
    v_and_b32 v39, 0xffff0000, v107
    v_lshlrev_b32 v40, 16, v108
    v_and_b32 v41, 0xffff0000, v108
    v_lshlrev_b32 v42, 16, v109
    v_and_b32 v43, 0xffff0000, v109
    v_lshlrev_b32 v44, 16, v110
    v_and_b32 v45, 0xffff0000, v110
    v_lshlrev_b32 v46, 16, v111
    v_and_b32 v47, 0xffff0000, v111
    v_lshlrev_b32 v48, 16, v112
    v_and_b32 v49, 0xffff0000, v112
    v_lshlrev_b32 v50, 16, v113
    v_and_b32 v51, 0xffff0000, v113
    v_lshlrev_b32 v52, 16, v114
    v_and_b32 v53, 0xffff0000, v114
    v_lshlrev_b32 v54, 16, v115
    v_and_b32 v55, 0xffff0000, v115
p_now1:
    s_setprio 0
    v_lshrrev_b32 v16, 3, v0
    v_lshlrev_b32 v16, 7, v16
    v_bfe_u32 v17, v0, 1, 2
    v_lshl_add_u32 v16, v17, 4, v16
    v_add_u32 v16, 77824, v16
    v_add_u32 v17, 4096, v16
    v_mov_b32 v60, 80032
lw_p3:
    ds_read_b32 v61, v60
    s_waitcnt lgkmcnt(0)
    v_readfirstlane_b32 s62, v61
    s_cmp_ge_u32 s62, 1
    s_cbranch_scc1 lw_p3_done
    s_sleep 1
    s_branch lw_p3
lw_p3_done:
    s_cmp_lt_u32 s2, 86
    s_cbranch_scc0 p_hplain
    global_load_dwordx4 v[64:67], v4, s[22:23] sc1
    global_load_dwordx4 v[68:71], v5, s[22:23] sc1
    global_load_dwordx4 v[72:75], v5, s[22:23] offset:16 sc1
    global_load_dword v76, v6, s[22:23] sc1
    global_load_dword v77, v13, s[22:23] sc1
    global_load_dword v78, v14, s[22:23] sc1
    global_load_dwordx4 v[100:103], v16, s[22:23] sc1
    global_load_dwordx4 v[104:107], v17, s[22:23] sc1
    s_waitcnt vmcnt(7)
    ds_write_b128 v8, v[64:67]
    v_lshlrev_b32 v80, 16, v64
    v_and_b32 v81, 0xffff0000, v64
    v_lshlrev_b32 v82, 16, v65
    v_and_b32 v83, 0xffff0000, v65
    v_lshlrev_b32 v84, 16, v66
    v_and_b32 v85, 0xffff0000, v66
    v_lshlrev_b32 v86, 16, v67
    v_and_b32 v87, 0xffff0000, v67
    s_waitcnt vmcnt(5)
    v_lshlrev_b32 v12, 16, v68
    v_and_b32 v68, 0xffff0000, v68
    v_fma_f32 v80, v80, v12, v68
    v_lshlrev_b32 v13, 16, v69
    v_and_b32 v69, 0xffff0000, v69
    v_fma_f32 v81, v81, v13, v69
    v_lshlrev_b32 v14, 16, v70
    v_and_b32 v70, 0xffff0000, v70
    v_fma_f32 v82, v82, v14, v70
    v_lshlrev_b32 v15, 16, v71
    v_and_b32 v71, 0xffff0000, v71
    v_fma_f32 v83, v83, v15, v71
    v_lshlrev_b32 v12, 16, v72
    v_and_b32 v72, 0xffff0000, v72
    v_fma_f32 v84, v84, v12, v72
    v_lshlrev_b32 v13, 16, v73
    v_and_b32 v73, 0xffff0000, v73
    v_fma_f32 v85, v85, v13, v73
    v_lshlrev_b32 v14, 16, v74
    v_and_b32 v74, 0xffff0000, v74
    v_fma_f32 v86, v86, v14, v74
    v_lshlrev_b32 v15, 16, v75
    v_and_b32 v75, 0xffff0000, v75
    v_fma_f32 v87, v87, v15, v75
    s_waitcnt vmcnt(2)
    v_add_f32 v77, 1.0, v77
    v_cvt_pk_bf16_f32 v77, v77, v77
    ds_write_b32 v9, v78
    v_lshlrev_b32 v77, 16, v77
    v_fma_f32 v80, v80, v77, v76
    v_fma_f32 v81, v81, v77, v76
    v_fma_f32 v82, v82, v77, v76
    v_fma_f32 v83, v83, v77, v76
    v_fma_f32 v84, v84, v77, v76
    v_fma_f32 v85, v85, v77, v76
    v_fma_f32 v86, v86, v77, v76
    v_fma_f32 v87, v87, v77, v76
    v_cvt_pk_bf16_f32 v88, v80, v81
    v_cvt_pk_bf16_f32 v89, v82, v83
    v_cvt_pk_bf16_f32 v90, v84, v85
    v_cvt_pk_bf16_f32 v91, v86, v87
    ds_write_b128 v7, v[88:91]
    s_waitcnt lgkmcnt(0)
    s_branch p_hdone
p_hplain:
    global_load_dwordx4 v[64:67], v4, s[22:23] sc1
    global_load_dwordx4 v[68:71], v5, s[22:23] sc1
    global_load_dwordx4 v[72:75], v5, s[22:23] offset:16 sc1
    global_load_dword v76, v6, s[22:23] sc1
    global_load_dword v77, v13, s[22:23] sc1
    global_load_dword v78, v14, s[22:23] sc1
    s_waitcnt vmcnt(5)
    ds_write_b128 v8, v[64:67]
    v_lshlrev_b32 v80, 16, v64
    v_and_b32 v81, 0xffff0000, v64
    v_lshlrev_b32 v82, 16, v65
    v_and_b32 v83, 0xffff0000, v65
    v_lshlrev_b32 v84, 16, v66
    v_and_b32 v85, 0xffff0000, v66
    v_lshlrev_b32 v86, 16, v67
    v_and_b32 v87, 0xffff0000, v67
    s_waitcnt vmcnt(3)
    v_lshlrev_b32 v12, 16, v68
    v_and_b32 v68, 0xffff0000, v68
    v_fma_f32 v80, v80, v12, v68
    v_lshlrev_b32 v13, 16, v69
    v_and_b32 v69, 0xffff0000, v69
    v_fma_f32 v81, v81, v13, v69
    v_lshlrev_b32 v14, 16, v70
    v_and_b32 v70, 0xffff0000, v70
    v_fma_f32 v82, v82, v14, v70
    v_lshlrev_b32 v15, 16, v71
    v_and_b32 v71, 0xffff0000, v71
    v_fma_f32 v83, v83, v15, v71
    v_lshlrev_b32 v12, 16, v72
    v_and_b32 v72, 0xffff0000, v72
    v_fma_f32 v84, v84, v12, v72
    v_lshlrev_b32 v13, 16, v73
    v_and_b32 v73, 0xffff0000, v73
    v_fma_f32 v85, v85, v13, v73
    v_lshlrev_b32 v14, 16, v74
    v_and_b32 v74, 0xffff0000, v74
    v_fma_f32 v86, v86, v14, v74
    v_lshlrev_b32 v15, 16, v75
    v_and_b32 v75, 0xffff0000, v75
    v_fma_f32 v87, v87, v15, v75
    s_waitcnt vmcnt(0)
    v_add_f32 v77, 1.0, v77
    v_cvt_pk_bf16_f32 v77, v77, v77
    ds_write_b32 v9, v78
    v_lshlrev_b32 v77, 16, v77
    v_fma_f32 v80, v80, v77, v76
    v_fma_f32 v81, v81, v77, v76
    v_fma_f32 v82, v82, v77, v76
    v_fma_f32 v83, v83, v77, v76
    v_fma_f32 v84, v84, v77, v76
    v_fma_f32 v85, v85, v77, v76
    v_fma_f32 v86, v86, v77, v76
    v_fma_f32 v87, v87, v77, v76
    v_cvt_pk_bf16_f32 v88, v80, v81
    v_cvt_pk_bf16_f32 v89, v82, v83
    v_cvt_pk_bf16_f32 v90, v84, v85
    v_cvt_pk_bf16_f32 v91, v86, v87
    ds_write_b128 v7, v[88:91]
    s_waitcnt lgkmcnt(0)
p_hdone:
    s_barrier
    s_lshr_b32 s47, s2, 3
    s_mul_i32 s47, s47, 44032
    v_lshlrev_b32 v20, 6, v0
    v_add_u32 v20, s47, v20
    global_load_dword v21, v20, s[48:49]
    v_add_u32 v20, 16384, v20
    global_load_dword v22, v20, s[48:49]
    s_add_u32 s47, s47, 43968
    v_add_u32 v20, 16384, v20
    v_min_u32 v20, s47, v20
    global_load_dword v23, v20, s[48:49]
    s_cmp_lt_u32 s2, 86
    s_cbranch_scc0 p_done
    s_waitcnt vmcnt(3)
    v_add_f32 v12, 1.0, v104
    v_add_f32 v13, 1.0, v105
    v_add_f32 v14, 1.0, v106
    v_add_f32 v15, 1.0, v107
    v_cvt_pk_bf16_f32 v16, v12, v13
    v_cvt_pk_bf16_f32 v17, v14, v15
    v_lshlrev_b32 v12, 16, v16
    v_and_b32 v13, 0xffff0000, v16
    v_lshlrev_b32 v14, 16, v17
    v_and_b32 v15, 0xffff0000, v17
    v_mul_f32 v72, v100, v24
    v_mul_f32 v73, v100, v25
    v_mul_f32 v74, v100, v26
    v_mul_f32 v75, v100, v27
    v_mul_f32 v76, v100, v28
    v_mul_f32 v77, v100, v29
    v_mul_f32 v78, v100, v30
    v_mul_f32 v79, v100, v31
    v_fmac_f32 v72, v101, v32
    v_fmac_f32 v73, v101, v33
    v_fmac_f32 v74, v101, v34
    v_fmac_f32 v75, v101, v35
    v_fmac_f32 v76, v101, v36
    v_fmac_f32 v77, v101, v37
    v_fmac_f32 v78, v101, v38
    v_fmac_f32 v79, v101, v39
    v_fmac_f32 v72, v102, v40
    v_fmac_f32 v73, v102, v41
    v_fmac_f32 v74, v102, v42
    v_fmac_f32 v75, v102, v43
    v_fmac_f32 v76, v102, v44
    v_fmac_f32 v77, v102, v45
    v_fmac_f32 v78, v102, v46
    v_fmac_f32 v79, v102, v47
    v_fmac_f32 v72, v103, v48
    v_fmac_f32 v73, v103, v49
    v_fmac_f32 v74, v103, v50
    v_fmac_f32 v75, v103, v51
    v_fmac_f32 v76, v103, v52
    v_fmac_f32 v77, v103, v53
    v_fmac_f32 v78, v103, v54
    v_fmac_f32 v79, v103, v55
    v_mul_f32 v24, v12, v24
    v_mul_f32 v25, v12, v25
    v_mul_f32 v26, v12, v26
    v_mul_f32 v27, v12, v27
    v_mul_f32 v28, v12, v28
    v_mul_f32 v29, v12, v29
    v_mul_f32 v30, v12, v30
    v_mul_f32 v31, v12, v31
    v_mul_f32 v32, v13, v32
    v_mul_f32 v33, v13, v33
    v_mul_f32 v34, v13, v34
    v_mul_f32 v35, v13, v35
    v_mul_f32 v36, v13, v36
    v_mul_f32 v37, v13, v37
    v_mul_f32 v38, v13, v38
    v_mul_f32 v39, v13, v39
    v_mul_f32 v40, v14, v40
    v_mul_f32 v41, v14, v41
    v_mul_f32 v42, v14, v42
    v_mul_f32 v43, v14, v43
    v_mul_f32 v44, v14, v44
    v_mul_f32 v45, v14, v45
    v_mul_f32 v46, v14, v46
    v_mul_f32 v47, v14, v47
    v_mul_f32 v48, v15, v48
    v_mul_f32 v49, v15, v49
    v_mul_f32 v50, v15, v50
    v_mul_f32 v51, v15, v51
    v_mul_f32 v52, v15, v52
    v_mul_f32 v53, v15, v53
    v_mul_f32 v54, v15, v54
    v_mul_f32 v55, v15, v55
    v_cvt_pk_bf16_f32 v80, v24, v32
    v_cvt_pk_bf16_f32 v81, v40, v48
    v_cvt_pk_bf16_f32 v82, v25, v33
    v_cvt_pk_bf16_f32 v83, v41, v49
    v_cvt_pk_bf16_f32 v84, v26, v34
    v_cvt_pk_bf16_f32 v85, v42, v50
    v_cvt_pk_bf16_f32 v86, v27, v35
    v_cvt_pk_bf16_f32 v87, v43, v51
    v_cvt_pk_bf16_f32 v88, v28, v36
    v_cvt_pk_bf16_f32 v89, v44, v52
    v_cvt_pk_bf16_f32 v90, v29, v37
    v_cvt_pk_bf16_f32 v91, v45, v53
    v_cvt_pk_bf16_f32 v92, v30, v38
    v_cvt_pk_bf16_f32 v93, v46, v54
    v_cvt_pk_bf16_f32 v94, v31, v39
    v_cvt_pk_bf16_f32 v95, v47, v55
    ds_write_b64 v58, v[80:81] offset:0
    ds_write_b64 v58, v[82:83] offset:16
    ds_write_b64 v58, v[84:85] offset:32
    ds_write_b64 v58, v[86:87] offset:48
    ds_write_b64 v58, v[88:89] offset:64
    ds_write_b64 v58, v[90:91] offset:80
    ds_write_b64 v58, v[92:93] offset:96
    ds_write_b64 v58, v[94:95] offset:112
    v_dot2_f32_bf16 v64, v80, v57, 0
    v_dot2_f32_bf16 v65, v82, v57, 0
    v_dot2_f32_bf16 v66, v84, v57, 0
    v_dot2_f32_bf16 v67, v86, v57, 0
    v_dot2_f32_bf16 v68, v88, v57, 0
    v_dot2_f32_bf16 v69, v90, v57, 0
    v_dot2_f32_bf16 v70, v92, v57, 0
    v_dot2_f32_bf16 v71, v94, v57, 0
    v_dot2_f32_bf16 v64, v81, v57, v64
    v_dot2_f32_bf16 v65, v83, v57, v65
    v_dot2_f32_bf16 v66, v85, v57, v66
    v_dot2_f32_bf16 v67, v87, v57, v67
    v_dot2_f32_bf16 v68, v89, v57, v68
    v_dot2_f32_bf16 v69, v91, v57, v69
    v_dot2_f32_bf16 v70, v93, v57, v70
    v_dot2_f32_bf16 v71, v95, v57, v71
    s_nop 2
    v_add_f32_dpp v64, v64, v64 row_shr:2 row_mask:0xf bank_mask:0xf
    v_add_f32_dpp v65, v65, v65 row_shr:2 row_mask:0xf bank_mask:0xf
    v_add_f32_dpp v66, v66, v66 row_shr:2 row_mask:0xf bank_mask:0xf
    v_add_f32_dpp v67, v67, v67 row_shr:2 row_mask:0xf bank_mask:0xf
    v_add_f32_dpp v68, v68, v68 row_shr:2 row_mask:0xf bank_mask:0xf
    v_add_f32_dpp v69, v69, v69 row_shr:2 row_mask:0xf bank_mask:0xf
    v_add_f32_dpp v70, v70, v70 row_shr:2 row_mask:0xf bank_mask:0xf
    v_add_f32_dpp v71, v71, v71 row_shr:2 row_mask:0xf bank_mask:0xf
    v_add_f32_dpp v72, v72, v72 row_shr:2 row_mask:0xf bank_mask:0xf
    v_add_f32_dpp v73, v73, v73 row_shr:2 row_mask:0xf bank_mask:0xf
    v_add_f32_dpp v74, v74, v74 row_shr:2 row_mask:0xf bank_mask:0xf
    v_add_f32_dpp v75, v75, v75 row_shr:2 row_mask:0xf bank_mask:0xf
    v_add_f32_dpp v76, v76, v76 row_shr:2 row_mask:0xf bank_mask:0xf
    v_add_f32_dpp v77, v77, v77 row_shr:2 row_mask:0xf bank_mask:0xf
    v_add_f32_dpp v78, v78, v78 row_shr:2 row_mask:0xf bank_mask:0xf
    v_add_f32_dpp v79, v79, v79 row_shr:2 row_mask:0xf bank_mask:0xf
    v_add_f32_dpp v64, v64, v64 row_shr:4 row_mask:0xf bank_mask:0xf
    v_add_f32_dpp v65, v65, v65 row_shr:4 row_mask:0xf bank_mask:0xf
    v_add_f32_dpp v66, v66, v66 row_shr:4 row_mask:0xf bank_mask:0xf
    v_add_f32_dpp v67, v67, v67 row_shr:4 row_mask:0xf bank_mask:0xf
    v_add_f32_dpp v68, v68, v68 row_shr:4 row_mask:0xf bank_mask:0xf
    v_add_f32_dpp v69, v69, v69 row_shr:4 row_mask:0xf bank_mask:0xf
    v_add_f32_dpp v70, v70, v70 row_shr:4 row_mask:0xf bank_mask:0xf
    v_add_f32_dpp v71, v71, v71 row_shr:4 row_mask:0xf bank_mask:0xf
    v_add_f32_dpp v72, v72, v72 row_shr:4 row_mask:0xf bank_mask:0xf
    v_add_f32_dpp v73, v73, v73 row_shr:4 row_mask:0xf bank_mask:0xf
    v_add_f32_dpp v74, v74, v74 row_shr:4 row_mask:0xf bank_mask:0xf
    v_add_f32_dpp v75, v75, v75 row_shr:4 row_mask:0xf bank_mask:0xf
    v_add_f32_dpp v76, v76, v76 row_shr:4 row_mask:0xf bank_mask:0xf
    v_add_f32_dpp v77, v77, v77 row_shr:4 row_mask:0xf bank_mask:0xf
    v_add_f32_dpp v78, v78, v78 row_shr:4 row_mask:0xf bank_mask:0xf
    v_add_f32_dpp v79, v79, v79 row_shr:4 row_mask:0xf bank_mask:0xf
    v_add_f32_dpp v64, v64, v64 row_shr:8 row_mask:0xf bank_mask:0xf
    v_add_f32_dpp v65, v65, v65 row_shr:8 row_mask:0xf bank_mask:0xf
    v_add_f32_dpp v66, v66, v66 row_shr:8 row_mask:0xf bank_mask:0xf
    v_add_f32_dpp v67, v67, v67 row_shr:8 row_mask:0xf bank_mask:0xf
    v_add_f32_dpp v68, v68, v68 row_shr:8 row_mask:0xf bank_mask:0xf
    v_add_f32_dpp v69, v69, v69 row_shr:8 row_mask:0xf bank_mask:0xf
    v_add_f32_dpp v70, v70, v70 row_shr:8 row_mask:0xf bank_mask:0xf
    v_add_f32_dpp v71, v71, v71 row_shr:8 row_mask:0xf bank_mask:0xf
    v_add_f32_dpp v72, v72, v72 row_shr:8 row_mask:0xf bank_mask:0xf
    v_add_f32_dpp v73, v73, v73 row_shr:8 row_mask:0xf bank_mask:0xf
    v_add_f32_dpp v74, v74, v74 row_shr:8 row_mask:0xf bank_mask:0xf
    v_add_f32_dpp v75, v75, v75 row_shr:8 row_mask:0xf bank_mask:0xf
    v_add_f32_dpp v76, v76, v76 row_shr:8 row_mask:0xf bank_mask:0xf
    v_add_f32_dpp v77, v77, v77 row_shr:8 row_mask:0xf bank_mask:0xf
    v_add_f32_dpp v78, v78, v78 row_shr:8 row_mask:0xf bank_mask:0xf
    v_add_f32_dpp v79, v79, v79 row_shr:8 row_mask:0xf bank_mask:0xf
    v_lshrrev_b32 v5, 4, v0
    v_mul_u32_u24 v5, 144, v5
    v_lshl_add_u32 v5, v19, 5, v5
    v_add_u32 v5, 96512, v5
    v_and_b32 v6, 15, v0
    v_cmp_lt_u32 vcc, 13, v6
    s_and_saveexec_b64 s[54:55], vcc
    ds_write_b128 v5, v[64:67]
    ds_write_b128 v5, v[68:71] offset:16
    ds_write_b128 v5, v[72:75] offset:64
    ds_write_b128 v5, v[76:79] offset:80
    s_mov_b64 exec, s[54:55]
    v_mov_b32 v60, 80044
    v_mov_b32 v61, 1
    s_mov_b64 exec, 1
    ds_add_u32 v60, v61
    s_mov_b64 exec, -1
    v_lshlrev_b32 v7, 4, v0
    v_add_u32 v7, 80128, v7
    s_lshr_b32 s13, s2, 1
    s_lshl_b32 s13, s13, 15
    s_and_b32 s14, s2, 1
    s_lshl_b32 s14, s14, 8
    s_add_u32 s13, s13, s14
    s_add_u32 s13, s13, 10485760
    v_lshrrev_b32 v8, 4, v0
    v_lshlrev_b32 v8, 9, v8
    v_lshl_add_u32 v8, v6, 4, v8
    v_add_u32 v8, s13, v8
    v_lshlrev_b32 v9, 2, v6
    v_bfe_u32 v10, v0, 4, 1
    v_lshl_add_u32 v9, v10, 6, v9
    v_add_u32 v9, 96512, v9
    v_mov_b32 v60, 80044
lw_p7:
    ds_read_b32 v61, v60
    s_waitcnt lgkmcnt(0)
    v_readfirstlane_b32 s62, v61
    s_cmp_ge_u32 s62, 4
    s_cbranch_scc1 lw_p7_done
    s_sleep 1
    s_branch lw_p7
lw_p7_done:
    ds_read_b128 v[24:27], v7 offset:0
    ds_read_b128 v[28:31], v7 offset:4096
    ds_read_b128 v[32:35], v7 offset:8192
    ds_read_b128 v[36:39], v7 offset:12288
    ds_read_b32 v40, v9 offset:0
    ds_read_b32 v41, v9 offset:144
    ds_read_b32 v42, v9 offset:288
    ds_read_b32 v43, v9 offset:432
    ds_read_b32 v44, v9 offset:576
    ds_read_b32 v45, v9 offset:720
    ds_read_b32 v46, v9 offset:864
    ds_read_b32 v47, v9 offset:1008
    ds_read_b32 v48, v9 offset:1152
    ds_read_b32 v49, v9 offset:1296
    ds_read_b32 v50, v9 offset:1440
    ds_read_b32 v51, v9 offset:1584
    ds_read_b32 v52, v9 offset:1728
    ds_read_b32 v53, v9 offset:1872
    ds_read_b32 v54, v9 offset:2016
    ds_read_b32 v55, v9 offset:2160
    s_waitcnt lgkmcnt(0)
    global_store_dwordx4 v8, v[24:27], s[22:23] sc1
    v_add_u32 v8, 8192, v8
    global_store_dwordx4 v8, v[28:31], s[22:23] sc1
    v_add_u32 v8, 8192, v8
    global_store_dwordx4 v8, v[32:35], s[22:23] sc1
    v_add_u32 v8, 8192, v8
    global_store_dwordx4 v8, v[36:39], s[22:23] sc1
    v_add_f32 v40, v40, v41
    v_add_f32 v42, v42, v43
    v_add_f32 v44, v44, v45
    v_add_f32 v46, v46, v47
    v_add_f32 v48, v48, v49
    v_add_f32 v50, v50, v51
    v_add_f32 v52, v52, v53
    v_add_f32 v54, v54, v55
    v_add_f32 v40, v40, v42
    v_add_f32 v44, v44, v46
    v_add_f32 v48, v48, v50
    v_add_f32 v52, v52, v54
    v_add_f32 v40, v40, v44
    v_add_f32 v48, v48, v52
    v_add_f32 v40, v40, v48
    v_lshlrev_b32 v56, 16, v56
    v_cmp_eq_u32 vcc, 1, v10
    s_nop 1
    v_cndmask_b32 v56, 0, v56, vcc
    v_add_f32 v40, v40, v56
    s_lshl_b32 s13, s2, 6
    v_lshl_add_u32 v11, v6, 2, s13
    v_mov_b32 v12, 32768
    v_mov_b32 v13, 40960
    v_cndmask_b32 v12, v12, v13, vcc
    v_add_u32 v11, v11, v12
    v_cmp_gt_u32 vcc, 32, v0
    s_and_saveexec_b64 s[54:55], vcc
    s_cbranch_execz p_done
    global_store_dword v11, v40, s[22:23] sc1
p_done:
    s_mov_b64 exec, -1
    v_add_u32 v0, 256, v0
    s_waitcnt vmcnt(0)
    s_branch mega_next
kwaves:
    s_setprio 3
    s_load_dwordx4 s[8:11], s[0:1], 8
    s_load_dwordx4 s[12:15], s[0:1], 24
    s_load_dwordx4 s[16:19], s[0:1], 40
    s_load_dwordx4 s[40:43], s[0:1], 56
    s_load_dwordx4 s[20:23], s[0:1], 136
    s_lshr_b32 s27, s26, 1
    s_and_b32 s28, s26, 1
    s_add_u32 s30, s29, s27
    s_lshl_b32 s34, s30, 8
    s_lshl_b32 s35, s28, 7
    s_add_u32 s34, s34, s35
    v_lshl_add_u32 v36, v1, 1, s34
    s_lshl_b32 s35, s29, 1
    s_waitcnt lgkmcnt(0)
    s_cmp_eq_u32 s2, 0
    s_cselect_b32 s62, s26, 0
    s_cmp_eq_u32 s62, 3
    s_cbranch_scc0 k_nozero
    v_lshlrev_b32 v60, 7, v1
    v_add_u32 v60, 188416, v60
    v_mov_b32 v62, 0
    v_mov_b32 v63, 0
    v_mov_b32 v64, 0
    v_mov_b32 v65, 0
    global_store_dwordx4 v60, v[62:65], s[22:23] sc1
    v_add_u32 v60, 8192, v60
    global_store_dwordx4 v60, v[62:65], s[22:23] sc1
k_nozero:
    global_load_ushort v40, v36, s[8:9]
    global_load_ushort v41, v36, s[10:11]
    global_load_ushort v42, v36, s[12:13]
    global_load_ushort v43, v36, s[14:15]
    global_load_ushort v44, v36, s[16:17]
    global_load_ushort v45, v36, s[18:19]
    s_load_dword s24, s[40:41], s35
    s_load_dword s25, s[42:43], s35
    s_getpc_b64 s[56:57]
idx_pc_k:
    s_add_u32 s56, s56, kidx_table-idx_pc_k
    s_addc_u32 s57, s57, 0
    v_mul_u32_u24 v110, 24, v0
    global_load_dwordx4 v[104:107], v110, s[56:57]
    global_load_dwordx2 v[108:109], v110, s[56:57] offset:16
    s_setprio 0
    s_waitcnt lgkmcnt(0)
    s_lshl_b32 s36, s27, 4
    s_lshr_b32 s24, s24, s36
    s_lshl_b32 s24, s24, 16
    s_lshr_b32 s25, s25, s36
    s_lshl_b32 s25, s25, 16
    v_mov_b32 v5, s24
    v_mul_f32 v6, 0x3fb8aa3b, v5
    s_mov_b32 s36, 0x3fb8aa3b
    v_fma_f32 v7, v5, s36, -v6
    v_fmac_f32 v7, 0x32a5705f, v5
    v_exp_f32 v6, v6
    v_mul_f32 v7, 0x3f317218, v7
    v_fmac_f32 v6, v6, v7
    v_cvt_pk_bf16_f32 v6, v6, v6
    v_lshlrev_b32 v6, 16, v6
    s_mul_i32 s36, s27, 31008
    s_lshl_b32 s37, s28, 8
    s_add_u32 s36, s36, s37
    v_lshl_add_u32 v2, v1, 2, s36
    v_mov_b32 v4, 0
    v_mov_b32 v5, 75328
    ds_write_b32 v5, v4
    ds_write_b32 v5, v4 offset:3104
    s_waitcnt vmcnt(6)
    v_lshlrev_b32 v40, 16, v40
    v_lshlrev_b32 v41, 16, v41
    v_mul_f32 v10, v6, v40
    v_mul_f32 v11, v6, v41
    v_mul_f32 v10, 0x3fb8aa3b, v10
    v_mul_f32 v11, 0x3e22f983, v11
    v_mul_f32 v28, 0x3f800000, v10
    v_mul_f32 v29, 0x3f800000, v11
    v_exp_f32 v28, v28
    v_fract_f32 v29, v29
    v_cos_f32 v64, v29
    v_sin_f32 v65, v29
    s_nop 0
    v_mul_f32 v64, v28, v64
    v_mul_f32 v65, v28, v65
    v_mul_f32 v30, 0x43000000, v10
    v_mul_f32 v31, 0x43000000, v11
    v_exp_f32 v30, v30
    v_fract_f32 v31, v31
    v_cos_f32 v80, v31
    v_sin_f32 v81, v31
    s_nop 0
    v_mul_f32 v80, v30, v80
    v_mul_f32 v81, v30, v81
    s_waitcnt vmcnt(2)
    v_lshlrev_b32 v42, 16, v42
    v_lshlrev_b32 v43, 16, v43
    v_lshlrev_b32 v44, 16, v44
    v_lshlrev_b32 v45, 16, v45
    v_mul_f32 v42, v6, v42
    v_mul_f32 v43, v6, v43
    s_cmp_eq_u32 s2, 0
    s_cselect_b32 s62, s26, 0
    s_cmp_eq_u32 s62, 3
    s_cbranch_scc0 k_noflag
    v_lshlrev_b32 v60, 6, v1
    v_add_u32 v60, 4, v60
    v_mov_b32 v61, 1
    s_mov_b64 exec, 15
    global_atomic_add v60, v61, s[20:21] sc1
    s_mov_b64 exec, -1
k_noflag:
    v_pk_mul_f32 v[32:33], v[44:45], v[42:43] op_sel:[0,0] op_sel_hi:[0,1]
    v_pk_fma_f32 v[86:87], v[44:45], v[42:43], v[32:33] op_sel:[1,1,0] op_sel_hi:[1,0,1] neg_lo:[1,0,0]
    v_mov_b32 v62, 0x3f80
    ds_write_b32 v2, v62 offset:0
    v_pk_mul_f32 v[28:29], v[64:65], v[64:65] op_sel:[0,0] op_sel_hi:[0,1]
    v_pk_fma_f32 v[66:67], v[64:65], v[64:65], v[28:29] op_sel:[1,1,0] op_sel_hi:[1,0,1] neg_lo:[1,0,0]
    v_pk_mul_f32 v[30:31], v[80:81], v[80:81] op_sel:[0,0] op_sel_hi:[0,1]
    v_pk_fma_f32 v[82:83], v[80:81], v[80:81], v[30:31] op_sel:[1,1,0] op_sel_hi:[1,0,1] neg_lo:[1,0,0]
    v_cvt_pk_bf16_f32 v63, v64, v65
    ds_write_b32 v2, v63 offset:544
    v_cvt_pk_bf16_f32 v62, v80, v81
    ds_write_b32 v2, v62 offset:4352
    v_cvt_pk_bf16_f32 v63, v86, -v87
    ds_write_b32 v2, v63 offset:22304
    v_pk_mul_f32 v[28:29], v[66:67], v[66:67] op_sel:[0,0] op_sel_hi:[0,1]
    v_pk_fma_f32 v[70:71], v[66:67], v[66:67], v[28:29] op_sel:[1,1,0] op_sel_hi:[1,0,1] neg_lo:[1,0,0]
    v_pk_mul_f32 v[30:31], v[66:67], v[64:65] op_sel:[0,0] op_sel_hi:[0,1]
    v_pk_fma_f32 v[68:69], v[66:67], v[64:65], v[30:31] op_sel:[1,1,0] op_sel_hi:[1,0,1] neg_lo:[1,0,0]
    v_pk_mul_f32 v[32:33], v[82:83], v[82:83] op_sel:[0,0] op_sel_hi:[0,1]
    v_pk_fma_f32 v[88:89], v[82:83], v[82:83], v[32:33] op_sel:[1,1,0] op_sel_hi:[1,0,1] neg_lo:[1,0,0]
    v_cvt_pk_bf16_f32 v62, v66, v67
    ds_write_b32 v2, v62 offset:1088
    v_cvt_pk_bf16_f32 v63, v82, v83
    ds_write_b32 v2, v63 offset:8704
    v_pk_mul_f32 v[28:29], v[70:71], v[70:71] op_sel:[0,0] op_sel_hi:[0,1]
    v_pk_fma_f32 v[78:79], v[70:71], v[70:71], v[28:29] op_sel:[1,1,0] op_sel_hi:[1,0,1] neg_lo:[1,0,0]
    v_pk_mul_f32 v[30:31], v[70:71], v[64:65] op_sel:[0,0] op_sel_hi:[0,1]
    v_pk_fma_f32 v[72:73], v[70:71], v[64:65], v[30:31] op_sel:[1,1,0] op_sel_hi:[1,0,1] neg_lo:[1,0,0]
    v_pk_mul_f32 v[32:33], v[68:69], v[68:69] op_sel:[0,0] op_sel_hi:[0,1]
    v_pk_fma_f32 v[74:75], v[68:69], v[68:69], v[32:33] op_sel:[1,1,0] op_sel_hi:[1,0,1] neg_lo:[1,0,0]
    v_cvt_pk_bf16_f32 v62, v68, v69
    ds_write_b32 v2, v62 offset:1632
    v_cvt_pk_bf16_f32 v63, v70, v71
    ds_write_b32 v2, v63 offset:2176
    v_cvt_pk_bf16_f32 v62, v88, v89
    ds_write_b32 v2, v62 offset:13056
    v_pk_mul_f32 v[28:29], v[70:71], v[68:69] op_sel:[0,0] op_sel_hi:[0,1]
    v_pk_fma_f32 v[76:77], v[70:71], v[68:69], v[28:29] op_sel:[1,1,0] op_sel_hi:[1,0,1] neg_lo:[1,0,0]
    v_pk_mul_f32 v[30:31], v[88:89], v[70:71] op_sel:[0,0] op_sel_hi:[0,1]
    v_pk_fma_f32 v[84:85], v[88:89], v[70:71], v[30:31] op_sel:[1,1,0] op_sel_hi:[1,0,1] neg_lo:[1,0,0]
    v_pk_mul_f32 v[32:33], v[82:83], v[66:67] op_sel:[0,0] op_sel_hi:[0,1]
    v_pk_fma_f32 v[14:15], v[82:83], v[66:67], v[32:33] op_sel:[1,1,0] op_sel_hi:[1,0,1] neg_lo:[1,0,0]
    v_pk_mul_f32 v[28:29], v[82:83], v[70:71] op_sel:[0,0] op_sel_hi:[0,1]
    v_pk_fma_f32 v[16:17], v[82:83], v[70:71], v[28:29] op_sel:[1,1,0] op_sel_hi:[1,0,1] neg_lo:[1,0,0]
    v_pk_mul_f32 v[30:31], v[82:83], v[74:75] op_sel:[0,0] op_sel_hi:[0,1]
    v_pk_fma_f32 v[18:19], v[82:83], v[74:75], v[30:31] op_sel:[1,1,0] op_sel_hi:[1,0,1] neg_lo:[1,0,0]
    v_cvt_pk_bf16_f32 v63, v72, v73
    ds_write_b32 v2, v63 offset:2720
    v_cvt_pk_bf16_f32 v62, v74, v75
    ds_write_b32 v2, v62 offset:3264
    v_cvt_pk_bf16_f32 v63, v76, v77
    ds_write_b32 v2, v63 offset:3808
    v_cvt_pk_bf16_f32 v62, v84, v85
    ds_write_b32 v2, v62 offset:13600
    v_pk_mul_f32 v[32:33], v[82:83], v[80:81] op_sel:[0,0] op_sel_hi:[0,1]
    v_pk_fma_f32 v[12:13], v[82:83], v[80:81], v[32:33] op_sel:[1,1,0] op_sel_hi:[1,0,1] neg_lo:[1,0,0]
    v_mov_b64 v[82:83], v[88:89]
    v_pk_mul_f32 v[28:29], v[88:89], v[88:89] op_sel:[0,0] op_sel_hi:[0,1]
    v_pk_fma_f32 v[88:89], v[88:89], v[88:89], v[28:29] op_sel:[1,1,0] op_sel_hi:[1,0,1] neg_lo:[1,0,0]
    v_cvt_pk_bf16_f32 v63, v14, v15
    ds_write_b32 v2, v63 offset:9248
    v_cvt_pk_bf16_f32 v62, v16, v17
    ds_write_b32 v2, v62 offset:9792
    v_cvt_pk_bf16_f32 v63, v18, v19
    ds_write_b32 v2, v63 offset:10336
    v_cvt_pk_bf16_f32 v62, v12, v13
    ds_write_b32 v2, v62 offset:10880
    v_pk_mul_f32 v[30:31], v[14:15], v[80:81] op_sel:[0,0] op_sel_hi:[0,1]
    v_pk_fma_f32 v[14:15], v[14:15], v[80:81], v[30:31] op_sel:[1,1,0] op_sel_hi:[1,0,1] neg_lo:[1,0,0]
    v_pk_mul_f32 v[32:33], v[16:17], v[80:81] op_sel:[0,0] op_sel_hi:[0,1]
    v_pk_fma_f32 v[16:17], v[16:17], v[80:81], v[32:33] op_sel:[1,1,0] op_sel_hi:[1,0,1] neg_lo:[1,0,0]
    v_pk_mul_f32 v[28:29], v[18:19], v[80:81] op_sel:[0,0] op_sel_hi:[0,1]
    v_pk_fma_f32 v[18:19], v[18:19], v[80:81], v[28:29] op_sel:[1,1,0] op_sel_hi:[1,0,1] neg_lo:[1,0,0]
    v_cvt_pk_bf16_f32 v63, v14, v15
    ds_write_b32 v2, v63 offset:11424
    v_cvt_pk_bf16_f32 v62, v16, v17
    ds_write_b32 v2, v62 offset:11968
    v_cvt_pk_bf16_f32 v63, v18, v19
    ds_write_b32 v2, v63 offset:12512
    v_cvt_pk_bf16_f32 v62, v88, v89
    ds_write_b32 v2, v62 offset:17408
    v_pk_mul_f32 v[28:29], v[86:87], v[78:79] op_sel:[0,0] op_sel_hi:[0,1]
    v_pk_fma_f32 v[86:87], v[86:87], v[78:79], v[28:29] op_sel:[1,1,0] op_sel_hi:[1,0,1] neg_lo:[1,0,0]
    v_pk_mul_f32 v[30:31], v[88:89], v[80:81] op_sel:[0,0] op_sel_hi:[0,1]
    v_pk_fma_f32 v[88:89], v[88:89], v[80:81], v[30:31] op_sel:[1,1,0] op_sel_hi:[1,0,1] neg_lo:[1,0,0]
    v_pk_mul_f32 v[32:33], v[80:81], v[64:65] op_sel:[0,0] op_sel_hi:[0,1]
    v_pk_fma_f32 v[12:13], v[80:81], v[64:65], v[32:33] op_sel:[1,1,0] op_sel_hi:[1,0,1] neg_lo:[1,0,0]
    v_pk_mul_f32 v[34:35], v[82:83], v[80:81] op_sel:[0,0] op_sel_hi:[0,1]
    v_pk_fma_f32 v[82:83], v[82:83], v[80:81], v[34:35] op_sel:[1,1,0] op_sel_hi:[1,0,1] neg_lo:[1,0,0]
    v_pk_mul_f32 v[36:37], v[84:85], v[80:81] op_sel:[0,0] op_sel_hi:[0,1]
    v_pk_fma_f32 v[84:85], v[84:85], v[80:81], v[36:37] op_sel:[1,1,0] op_sel_hi:[1,0,1] neg_lo:[1,0,0]
    v_cvt_pk_bf16_f32 v63, v86, -v87
    ds_write_b32 v2, v63 offset:22848
    v_cvt_pk_bf16_f32 v62, v88, v89
    ds_write_b32 v2, v62 offset:17952
    v_cvt_pk_bf16_f32 v63, v12, v13
    ds_write_b32 v2, v63 offset:4896
    v_cvt_pk_bf16_f32 v62, v82, v83
    ds_write_b32 v2, v62 offset:14144
    v_cvt_pk_bf16_f32 v63, v84, v85
    ds_write_b32 v2, v63 offset:14688
    v_pk_mul_f32 v[28:29], v[86:87], v[78:79] op_sel:[0,0] op_sel_hi:[0,1]
    v_pk_fma_f32 v[86:87], v[86:87], v[78:79], v[28:29] op_sel:[1,1,0] op_sel_hi:[1,0,1] neg_lo:[1,0,0]
    v_pk_mul_f32 v[30:31], v[88:89], v[80:81] op_sel:[0,0] op_sel_hi:[0,1]
    v_pk_fma_f32 v[88:89], v[88:89], v[80:81], v[30:31] op_sel:[1,1,0] op_sel_hi:[1,0,1] neg_lo:[1,0,0]
    v_pk_mul_f32 v[32:33], v[80:81], v[66:67] op_sel:[0,0] op_sel_hi:[0,1]
    v_pk_fma_f32 v[12:13], v[80:81], v[66:67], v[32:33] op_sel:[1,1,0] op_sel_hi:[1,0,1] neg_lo:[1,0,0]
    v_pk_mul_f32 v[34:35], v[82:83], v[80:81] op_sel:[0,0] op_sel_hi:[0,1]
    v_pk_fma_f32 v[82:83], v[82:83], v[80:81], v[34:35] op_sel:[1,1,0] op_sel_hi:[1,0,1] neg_lo:[1,0,0]
    v_pk_mul_f32 v[36:37], v[84:85], v[80:81] op_sel:[0,0] op_sel_hi:[0,1]
    v_pk_fma_f32 v[84:85], v[84:85], v[80:81], v[36:37] op_sel:[1,1,0] op_sel_hi:[1,0,1] neg_lo:[1,0,0]
    v_cvt_pk_bf16_f32 v62, v86, -v87
    ds_write_b32 v2, v62 offset:23392
    v_cvt_pk_bf16_f32 v63, v88, v89
    ds_write_b32 v2, v63 offset:18496
    v_cvt_pk_bf16_f32 v62, v12, v13
    ds_write_b32 v2, v62 offset:5440
    v_cvt_pk_bf16_f32 v63, v82, v83
    ds_write_b32 v2, v63 offset:15232
    v_cvt_pk_bf16_f32 v62, v84, v85
    ds_write_b32 v2, v62 offset:15776
    v_pk_mul_f32 v[28:29], v[86:87], v[78:79] op_sel:[0,0] op_sel_hi:[0,1]
    v_pk_fma_f32 v[86:87], v[86:87], v[78:79], v[28:29] op_sel:[1,1,0] op_sel_hi:[1,0,1] neg_lo:[1,0,0]
    v_pk_mul_f32 v[30:31], v[88:89], v[80:81] op_sel:[0,0] op_sel_hi:[0,1]
    v_pk_fma_f32 v[88:89], v[88:89], v[80:81], v[30:31] op_sel:[1,1,0] op_sel_hi:[1,0,1] neg_lo:[1,0,0]
    v_pk_mul_f32 v[32:33], v[80:81], v[68:69] op_sel:[0,0] op_sel_hi:[0,1]
    v_pk_fma_f32 v[12:13], v[80:81], v[68:69], v[32:33] op_sel:[1,1,0] op_sel_hi:[1,0,1] neg_lo:[1,0,0]
    v_pk_mul_f32 v[34:35], v[82:83], v[80:81] op_sel:[0,0] op_sel_hi:[0,1]
    v_pk_fma_f32 v[82:83], v[82:83], v[80:81], v[34:35] op_sel:[1,1,0] op_sel_hi:[1,0,1] neg_lo:[1,0,0]
    v_pk_mul_f32 v[36:37], v[84:85], v[80:81] op_sel:[0,0] op_sel_hi:[0,1]
    v_pk_fma_f32 v[84:85], v[84:85], v[80:81], v[36:37] op_sel:[1,1,0] op_sel_hi:[1,0,1] neg_lo:[1,0,0]
    v_cvt_pk_bf16_f32 v63, v86, -v87
    ds_write_b32 v2, v63 offset:23936
    v_cvt_pk_bf16_f32 v62, v88, v89
    ds_write_b32 v2, v62 offset:19040
    v_cvt_pk_bf16_f32 v63, v12, v13
    ds_write_b32 v2, v63 offset:5984
    v_cvt_pk_bf16_f32 v62, v82, v83
    ds_write_b32 v2, v62 offset:16320
    v_cvt_pk_bf16_f32 v63, v84, v85
    ds_write_b32 v2, v63 offset:16864
    v_pk_mul_f32 v[28:29], v[86:87], v[78:79] op_sel:[0,0] op_sel_hi:[0,1]
    v_pk_fma_f32 v[86:87], v[86:87], v[78:79], v[28:29] op_sel:[1,1,0] op_sel_hi:[1,0,1] neg_lo:[1,0,0]
    v_pk_mul_f32 v[30:31], v[88:89], v[80:81] op_sel:[0,0] op_sel_hi:[0,1]
    v_pk_fma_f32 v[88:89], v[88:89], v[80:81], v[30:31] op_sel:[1,1,0] op_sel_hi:[1,0,1] neg_lo:[1,0,0]
    v_pk_mul_f32 v[32:33], v[80:81], v[70:71] op_sel:[0,0] op_sel_hi:[0,1]
    v_pk_fma_f32 v[12:13], v[80:81], v[70:71], v[32:33] op_sel:[1,1,0] op_sel_hi:[1,0,1] neg_lo:[1,0,0]
    v_cvt_pk_bf16_f32 v62, v86, -v87
    ds_write_b32 v2, v62 offset:24480
    v_cvt_pk_bf16_f32 v63, v88, v89
    ds_write_b32 v2, v63 offset:19584
    v_cvt_pk_bf16_f32 v62, v12, v13
    ds_write_b32 v2, v62 offset:6528
    v_pk_mul_f32 v[28:29], v[86:87], v[78:79] op_sel:[0,0] op_sel_hi:[0,1]
    v_pk_fma_f32 v[86:87], v[86:87], v[78:79], v[28:29] op_sel:[1,1,0] op_sel_hi:[1,0,1] neg_lo:[1,0,0]
    v_pk_mul_f32 v[30:31], v[88:89], v[80:81] op_sel:[0,0] op_sel_hi:[0,1]
    v_pk_fma_f32 v[88:89], v[88:89], v[80:81], v[30:31] op_sel:[1,1,0] op_sel_hi:[1,0,1] neg_lo:[1,0,0]
    v_pk_mul_f32 v[32:33], v[80:81], v[72:73] op_sel:[0,0] op_sel_hi:[0,1]
    v_pk_fma_f32 v[12:13], v[80:81], v[72:73], v[32:33] op_sel:[1,1,0] op_sel_hi:[1,0,1] neg_lo:[1,0,0]
    v_cvt_pk_bf16_f32 v63, v86, -v87
    ds_write_b32 v2, v63 offset:25024
    v_cvt_pk_bf16_f32 v62, v88, v89
    ds_write_b32 v2, v62 offset:20128
    v_cvt_pk_bf16_f32 v63, v12, v13
    ds_write_b32 v2, v63 offset:7072
    v_pk_mul_f32 v[28:29], v[86:87], v[78:79] op_sel:[0,0] op_sel_hi:[0,1]
    v_pk_fma_f32 v[86:87], v[86:87], v[78:79], v[28:29] op_sel:[1,1,0] op_sel_hi:[1,0,1] neg_lo:[1,0,0]
    v_pk_mul_f32 v[30:31], v[88:89], v[80:81] op_sel:[0,0] op_sel_hi:[0,1]
    v_pk_fma_f32 v[88:89], v[88:89], v[80:81], v[30:31] op_sel:[1,1,0] op_sel_hi:[1,0,1] neg_lo:[1,0,0]
    v_pk_mul_f32 v[32:33], v[80:81], v[74:75] op_sel:[0,0] op_sel_hi:[0,1]
    v_pk_fma_f32 v[12:13], v[80:81], v[74:75], v[32:33] op_sel:[1,1,0] op_sel_hi:[1,0,1] neg_lo:[1,0,0]
    v_cvt_pk_bf16_f32 v62, v86, -v87
    ds_write_b32 v2, v62 offset:25568
    v_cvt_pk_bf16_f32 v63, v88, v89
    ds_write_b32 v2, v63 offset:20672
    v_cvt_pk_bf16_f32 v62, v12, v13
    ds_write_b32 v2, v62 offset:7616
    v_pk_mul_f32 v[28:29], v[86:87], v[78:79] op_sel:[0,0] op_sel_hi:[0,1]
    v_pk_fma_f32 v[86:87], v[86:87], v[78:79], v[28:29] op_sel:[1,1,0] op_sel_hi:[1,0,1] neg_lo:[1,0,0]
    v_pk_mul_f32 v[30:31], v[88:89], v[80:81] op_sel:[0,0] op_sel_hi:[0,1]
    v_pk_fma_f32 v[88:89], v[88:89], v[80:81], v[30:31] op_sel:[1,1,0] op_sel_hi:[1,0,1] neg_lo:[1,0,0]
    v_pk_mul_f32 v[32:33], v[80:81], v[76:77] op_sel:[0,0] op_sel_hi:[0,1]
    v_pk_fma_f32 v[12:13], v[80:81], v[76:77], v[32:33] op_sel:[1,1,0] op_sel_hi:[1,0,1] neg_lo:[1,0,0]
    v_cvt_pk_bf16_f32 v63, v86, -v87
    ds_write_b32 v2, v63 offset:26112
    v_cvt_pk_bf16_f32 v62, v88, v89
    ds_write_b32 v2, v62 offset:21216
    v_cvt_pk_bf16_f32 v63, v12, v13
    ds_write_b32 v2, v63 offset:8160
    v_pk_mul_f32 v[28:29], v[86:87], v[78:79] op_sel:[0,0] op_sel_hi:[0,1]
    v_pk_fma_f32 v[86:87], v[86:87], v[78:79], v[28:29] op_sel:[1,1,0] op_sel_hi:[1,0,1] neg_lo:[1,0,0]
    v_pk_mul_f32 v[30:31], v[88:89], v[80:81] op_sel:[0,0] op_sel_hi:[0,1]
    v_pk_fma_f32 v[88:89], v[88:89], v[80:81], v[30:31] op_sel:[1,1,0] op_sel_hi:[1,0,1] neg_lo:[1,0,0]
    v_cvt_pk_bf16_f32 v62, v86, -v87
    ds_write_b32 v2, v62 offset:26656
    v_cvt_pk_bf16_f32 v63, v88, v89
    ds_write_b32 v2, v63 offset:21760
    v_pk_mul_f32 v[28:29], v[86:87], v[78:79] op_sel:[0,0] op_sel_hi:[0,1]
    v_pk_fma_f32 v[86:87], v[86:87], v[78:79], v[28:29] op_sel:[1,1,0] op_sel_hi:[1,0,1] neg_lo:[1,0,0]
    v_cvt_pk_bf16_f32 v62, v86, -v87
    ds_write_b32 v2, v62 offset:27200
    v_pk_mul_f32 v[28:29], v[86:87], v[78:79] op_sel:[0,0] op_sel_hi:[0,1]
    v_pk_fma_f32 v[86:87], v[86:87], v[78:79], v[28:29] op_sel:[1,1,0] op_sel_hi:[1,0,1] neg_lo:[1,0,0]
    v_cvt_pk_bf16_f32 v63, v86, -v87
    ds_write_b32 v2, v63 offset:27744
    v_pk_mul_f32 v[28:29], v[86:87], v[78:79] op_sel:[0,0] op_sel_hi:[0,1]
    v_pk_fma_f32 v[86:87], v[86:87], v[78:79], v[28:29] op_sel:[1,1,0] op_sel_hi:[1,0,1] neg_lo:[1,0,0]
    v_cvt_pk_bf16_f32 v62, v86, -v87
    ds_write_b32 v2, v62 offset:28288
    v_pk_mul_f32 v[28:29], v[86:87], v[78:79] op_sel:[0,0] op_sel_hi:[0,1]
    v_pk_fma_f32 v[86:87], v[86:87], v[78:79], v[28:29] op_sel:[1,1,0] op_sel_hi:[1,0,1] neg_lo:[1,0,0]
    v_cvt_pk_bf16_f32 v63, v86, -v87
    ds_write_b32 v2, v63 offset:28832
    v_pk_mul_f32 v[28:29], v[86:87], v[78:79] op_sel:[0,0] op_sel_hi:[0,1]
    v_pk_fma_f32 v[86:87], v[86:87], v[78:79], v[28:29] op_sel:[1,1,0] op_sel_hi:[1,0,1] neg_lo:[1,0,0]
    v_cvt_pk_bf16_f32 v62, v86, -v87
    ds_write_b32 v2, v62 offset:29376
    v_pk_mul_f32 v[28:29], v[86:87], v[78:79] op_sel:[0,0] op_sel_hi:[0,1]
    v_pk_fma_f32 v[86:87], v[86:87], v[78:79], v[28:29] op_sel:[1,1,0] op_sel_hi:[1,0,1] neg_lo:[1,0,0]
    v_cvt_pk_bf16_f32 v63, v86, -v87
    ds_write_b32 v2, v63 offset:29920
    v_pk_mul_f32 v[28:29], v[86:87], v[78:79] op_sel:[0,0] op_sel_hi:[0,1]
    v_pk_fma_f32 v[86:87], v[86:87], v[78:79], v[28:29] op_sel:[1,1,0] op_sel_hi:[1,0,1] neg_lo:[1,0,0]
    v_cvt_pk_bf16_f32 v62, v86, -v87
    ds_write_b32 v2, v62 offset:30464
    v_and_b32 v4, 15, v0
    v_bfe_u32 v5, v0, 4, 2
    v_lshlrev_b32 v7, 4, v5
    v_mul_u32_u24 v8, 544, v4
    v_add_u32 v8, v8, v7
    s_mul_i32 s36, s27, 31008
    v_add_u32 v8, s36, v8
    v_add_u32 v9, 22304, v8
    s_mul_i32 s37, s28, 17408
    v_add_u32 v12, s37, v8
    s_mul_i32 s37, s28, 8704
    s_add_u32 s37, s37, 8704
    v_add_u32 v13, s37, v8
    v_mov_b32 v20, 0
    v_mov_b32 v21, 0
    v_mov_b32 v22, 0
    v_mov_b32 v23, 0
    v_mov_b32 v24, 0
    v_mov_b32 v25, 0
    v_mov_b32 v26, 0
    v_mov_b32 v27, 0
    v_mov_b32 v28, 0
    v_mov_b32 v29, 0
    v_mov_b32 v30, 0
    v_mov_b32 v31, 0
    v_mov_b32 v32, 0
    v_mov_b32 v33, 0
    v_mov_b32 v34, 0
    v_mov_b32 v35, 0
    s_mul_i32 s36, s27, 3104
    s_add_u32 s36, s36, 72256
    s_cmp_eq_u32 s28, 1
    s_cbranch_scc1 k_t2
    v_and_b32 v7, 1, v5
    v_lshlrev_b32 v7, 2, v7
    v_lshrrev_b32 v14, 1, v5
    v_lshl_add_u32 v7, v14, 7, v7
    v_lshl_add_u32 v7, v4, 3, v7
    v_lshl_add_u32 v14, v7, 2, s36
    v_add_u32 v15, 4, v14
    v_add_u32 v16, 8, v14
    v_add_u32 v17, 12, v14
    v_cmp_gt_u32 vcc, 2, v5
    v_lshlrev_b32 v7, 6, v5
    v_add_u32 v7, 256, v7
    v_lshlrev_b32 v40, 2, v4
    v_lshlrev_b32 v41, 1, v4
    v_cndmask_b32 v40, v41, v40, vcc
    v_add_u32 v7, v7, v40
    v_lshl_add_u32 v40, v7, 2, s36
    v_add_u32 v41, 4, v40
    v_mov_b32 v42, 128
    v_cndmask_b32 v42, v42, 8, vcc
    v_add_u32 v42, v40, v42
    v_add_u32 v43, 4, v42
    s_branch k_addr
k_t2:
    v_lshl_add_u32 v7, v5, 6, v4
    v_lshl_add_u32 v14, v7, 2, s36
    v_add_u32 v14, 2048, v14
    v_add_u32 v15, 64, v14
    v_add_u32 v16, 128, v14
    v_add_u32 v17, 192, v14
    v_mov_b32 v40, v14
    v_mov_b32 v41, v15
    v_mov_b32 v42, v16
    v_mov_b32 v43, v17
k_addr:
    v_cmp_eq_u32 vcc, 0, v1
    s_cmp_eq_u32 s28, 0
    s_cselect_b32 s25, s25, 0
    v_mov_b32 v7, s25
    v_cndmask_b32 v7, 0, v7, vcc
    s_waitcnt lgkmcnt(0)
    s_waitcnt vmcnt(0)
    v_and_b32 v112, 0xffff, v104
    v_lshrrev_b32 v113, 16, v104
    v_and_b32 v114, 0xffff, v105
    v_lshrrev_b32 v115, 16, v105
    v_and_b32 v116, 0xffff, v106
    v_lshrrev_b32 v117, 16, v106
    v_and_b32 v118, 0xffff, v107
    v_lshrrev_b32 v119, 16, v107
    v_and_b32 v120, 0xffff, v108
    v_lshrrev_b32 v121, 16, v108
    v_and_b32 v122, 0xffff, v109
    v_mov_b32 v38, 80024
    v_mov_b32 v39, 1
    s_mov_b64 exec, 1
    ds_add_u32 v38, v39
    s_mov_b64 exec, -1
    v_mov_b32 v38, 80024
lw_k1:
    ds_read_b32 v39, v38
    s_waitcnt lgkmcnt(0)
    v_readfirstlane_b32 s62, v39
    s_cmp_ge_u32 s62, 4
    s_cbranch_scc1 lw_k1_done
    s_sleep 1
    s_branch lw_k1
lw_k1_done:
    ds_read_b128 v[64:67], v9 offset:0
    ds_read_b128 v[68:71], v12 offset:0
    ds_read_b128 v[72:75], v13 offset:0
    ds_read_b128 v[76:79], v9 offset:64
    ds_read_b128 v[80:83], v12 offset:64
    ds_read_b128 v[84:87], v13 offset:64
    ds_read_b128 v[88:91], v9 offset:128
    ds_read_b128 v[92:95], v12 offset:128
    ds_read_b128 v[96:99], v13 offset:128
    ds_read_b128 v[100:103], v9 offset:192
    ds_read_b128 v[104:107], v12 offset:192
    ds_read_b128 v[108:111], v13 offset:192
    s_waitcnt lgkmcnt(9)
    v_mfma_f32_16x16x32_bf16 v[20:23], v[68:71], v[64:67], v[20:23]
    v_mfma_f32_16x16x32_bf16 v[24:27], v[72:75], v[64:67], v[24:27]
    ds_read_b128 v[64:67], v9 offset:256
    ds_read_b128 v[68:71], v12 offset:256
    ds_read_b128 v[72:75], v13 offset:256
    s_waitcnt lgkmcnt(9)
    v_mfma_f32_16x16x32_bf16 v[28:31], v[80:83], v[76:79], v[28:31]
    v_mfma_f32_16x16x32_bf16 v[32:35], v[84:87], v[76:79], v[32:35]
    ds_read_b128 v[76:79], v9 offset:320
    ds_read_b128 v[80:83], v12 offset:320
    ds_read_b128 v[84:87], v13 offset:320
    s_waitcnt lgkmcnt(9)
    v_mfma_f32_16x16x32_bf16 v[20:23], v[92:95], v[88:91], v[20:23]
    v_mfma_f32_16x16x32_bf16 v[24:27], v[96:99], v[88:91], v[24:27]
    ds_read_b128 v[88:91], v9 offset:384
    ds_read_b128 v[92:95], v12 offset:384
    ds_read_b128 v[96:99], v13 offset:384
    s_waitcnt lgkmcnt(9)
    v_mfma_f32_16x16x32_bf16 v[28:31], v[104:107], v[100:103], v[28:31]
    v_mfma_f32_16x16x32_bf16 v[32:35], v[108:111], v[100:103], v[32:35]
    ds_read_b128 v[100:103], v9 offset:448
    ds_read_b128 v[104:107], v12 offset:448
    ds_read_b128 v[108:111], v13 offset:448
    s_waitcnt lgkmcnt(9)
    v_mfma_f32_16x16x32_bf16 v[20:23], v[68:71], v[64:67], v[20:23]
    v_mfma_f32_16x16x32_bf16 v[24:27], v[72:75], v[64:67], v[24:27]
    s_waitcnt lgkmcnt(6)
    v_mfma_f32_16x16x32_bf16 v[28:31], v[80:83], v[76:79], v[28:31]
    v_mfma_f32_16x16x32_bf16 v[32:35], v[84:87], v[76:79], v[32:35]
    s_waitcnt lgkmcnt(3)
    v_mfma_f32_16x16x32_bf16 v[20:23], v[92:95], v[88:91], v[20:23]
    v_mfma_f32_16x16x32_bf16 v[24:27], v[96:99], v[88:91], v[24:27]
    s_waitcnt lgkmcnt(0)
    v_mfma_f32_16x16x32_bf16 v[28:31], v[104:107], v[100:103], v[28:31]
    v_mfma_f32_16x16x32_bf16 v[32:35], v[108:111], v[100:103], v[32:35]
    s_nop 7
    v_add_f32 v20, v20, v28
    v_add_f32 v21, v21, v29
    v_add_f32 v22, v22, v30
    v_add_f32 v23, v23, v31
    v_add_f32 v24, v24, v32
    v_add_f32 v25, v25, v33
    v_add_f32 v26, v26, v34
    v_add_f32 v27, v27, v35
    v_add_f32 v20, v20, v7
    ds_write_b32 v14, v20
    ds_write_b32 v15, v21
    ds_write_b32 v16, v22
    ds_write_b32 v17, v23
    ds_write_b32 v40, v24
    ds_write_b32 v41, v25
    ds_write_b32 v42, v26
    ds_write_b32 v43, v27
    v_mov_b32 v38, 80028
    v_mov_b32 v39, 1
    s_mov_b64 exec, 1
    ds_add_u32 v38, v39
    s_mov_b64 exec, -1
    v_mov_b32 v38, 80028
lw_k2:
    ds_read_b32 v39, v38
    s_waitcnt lgkmcnt(0)
    v_readfirstlane_b32 s62, v39
    s_cmp_ge_u32 s62, 4
    s_cbranch_scc1 lw_k2_done
    s_sleep 1
    s_branch lw_k2
lw_k2_done:
    ds_read_b32 v64, v112 offset:62428
    ds_read_b32 v65, v113 offset:62428
    ds_read_b32 v66, v114 offset:62428
    ds_read_b32 v67, v115 offset:62428
    ds_read_b32 v68, v116 offset:62428
    ds_read_b32 v69, v117 offset:62428
    ds_read_b32 v70, v118 offset:62428
    ds_read_b32 v71, v119 offset:62428
    ds_read_b32 v72, v120 offset:62428
    ds_read_b32 v73, v121 offset:62428
    ds_read_b32 v74, v122 offset:62428
    ds_read_b32 v76, v112 offset:65532
    ds_read_b32 v77, v113 offset:65532
    ds_read_b32 v78, v114 offset:65532
    ds_read_b32 v79, v115 offset:65532
    ds_read_b32 v80, v116 offset:65532
    ds_read_b32 v81, v117 offset:65532
    ds_read_b32 v82, v118 offset:65532
    ds_read_b32 v83, v119 offset:65532
    ds_read_b32 v84, v120 offset:65532
    ds_read_b32 v85, v121 offset:65532
    ds_read_b32 v86, v122 offset:65532
    v_lshlrev_b32 v4, 4, v0
    v_mov_b32 v56, 0
    v_mov_b32 v57, 0
    v_mov_b32 v58, 0
    v_mov_b32 v59, 0
    v_lshrrev_b32 v60, 1, v0
    v_mul_u32_u24 v60, 4160, v60
    v_and_b32 v61, 1, v0
    v_lshl_add_u32 v60, v61, 4, v60
    v_add_u32 v60, 4096, v60
    v_bfe_u32 v61, v0, 5, 1
    v_mul_u32_u24 v61, 4608, v61
    v_and_b32 v62, 31, v0
    v_lshl_add_u32 v61, v62, 4, v61
    v_add_u32 v61, 33280, v61
    v_cmp_gt_u32 vcc, 16, v0
    s_cmp_eq_u32 s26, 1
    s_cbranch_scc1 k_padh
    s_cmp_eq_u32 s26, 0
    s_cbranch_scc0 k_pad_done
    s_and_saveexec_b64 s[54:55], vcc
    ds_write_b128 v60, v[56:59]
    s_mov_b64 exec, s[54:55]
    s_branch k_pad_done
k_padh:
    ds_write_b128 v61, v[56:59]
k_pad_done:
    s_waitcnt lgkmcnt(0)
    v_cvt_pk_bf16_f32 v96, v64, v65
    v_cvt_pk_bf16_f32 v97, v66, v67
    v_cvt_pk_bf16_f32 v98, v68, v69
    v_cvt_pk_bf16_f32 v99, v70, v71
    ds_write_b128 v4, v[96:99] offset:0
    v_cvt_pk_bf16_f32 v100, v65, v66
    v_cvt_pk_bf16_f32 v101, v67, v68
    v_cvt_pk_bf16_f32 v102, v69, v70
    v_cvt_pk_bf16_f32 v103, v71, v72
    ds_write_b128 v4, v[100:103] offset:4160
    v_cvt_pk_bf16_f32 v96, v66, v67
    v_cvt_pk_bf16_f32 v97, v68, v69
    v_cvt_pk_bf16_f32 v98, v70, v71
    v_cvt_pk_bf16_f32 v99, v72, v73
    ds_write_b128 v4, v[96:99] offset:8320
    v_cvt_pk_bf16_f32 v100, v67, v68
    v_cvt_pk_bf16_f32 v101, v69, v70
    v_cvt_pk_bf16_f32 v102, v71, v72
    v_cvt_pk_bf16_f32 v103, v73, v74
    ds_write_b128 v4, v[100:103] offset:12480
    v_cvt_pk_bf16_f32 v96, v76, v77
    v_cvt_pk_bf16_f32 v97, v78, v79
    v_cvt_pk_bf16_f32 v98, v80, v81
    v_cvt_pk_bf16_f32 v99, v82, v83
    ds_write_b128 v4, v[96:99] offset:16640
    v_cvt_pk_bf16_f32 v100, v77, v78
    v_cvt_pk_bf16_f32 v101, v79, v80
    v_cvt_pk_bf16_f32 v102, v81, v82
    v_cvt_pk_bf16_f32 v103, v83, v84
    ds_write_b128 v4, v[100:103] offset:20800
    v_cvt_pk_bf16_f32 v96, v78, v79
    v_cvt_pk_bf16_f32 v97, v80, v81
    v_cvt_pk_bf16_f32 v98, v82, v83
    v_cvt_pk_bf16_f32 v99, v84, v85
    ds_write_b128 v4, v[96:99] offset:24960
    v_cvt_pk_bf16_f32 v100, v79, v80
    v_cvt_pk_bf16_f32 v101, v81, v82
    v_cvt_pk_bf16_f32 v102, v83, v84
    v_cvt_pk_bf16_f32 v103, v85, v86
    ds_write_b128 v4, v[100:103] offset:29120
    v_and_b32 v7, 15, v1
    v_lshrrev_b32 v2, 4, v1
    v_sub_u32 v60, 3, v7
    v_and_b32 v60, 3, v60
    v_mul_u32_u24 v61, 4158, v60
    v_lshlrev_b32 v62, 1, v7
    v_sub_u32 v61, v61, v62
    v_lshl_add_u32 v61, v2, 4, v61
    s_mul_i32 s38, s27, 16640
    s_lshl_b32 s39, s28, 8
    s_sub_u32 s38, s38, s39
    s_add_u32 s38, s38, 286
    v_add_u32 v20, s38, v61
    v_lshlrev_b32 v21, 5, v7
    v_lshl_add_u32 v21, v2, 4, v21
    s_mul_i32 s38, s27, 4608
    s_sub_u32 s38, s38, s39
    s_add_u32 s38, s38, 33568
    v_add_u32 v21, s38, v21
    v_lshlrev_b32 v22, 5, v7
    v_lshl_add_u32 v22, v2, 3, v22
    s_lshl_b32 s38, s27, 12
    s_lshl_b32 s39, s28, 11
    s_add_u32 s38, s38, s39
    s_add_u32 s38, s38, 42496
    v_add_u32 v23, s38, v22
    s_lshl_b32 s38, s30, 12
    s_lshl_b32 s39, s28, 11
    s_add_u32 s38, s38, s39
    s_add_u32 s38, s38, 12582912
    s_add_u32 s50, s22, s38
    s_addc_u32 s51, s23, 0
    s_lshl_b32 s43, s26, 12
    s_add_u32 s43, s43, 50688
    v_lshlrev_b32 v24, 4, v1
    v_add_u32 v25, s43, v24
    s_xor_b32 s43, s26, 1
    s_lshl_b32 s43, s43, 12
    s_add_u32 s43, s43, 50688
    v_add_u32 v26, s43, v24
    s_lshl_b32 s43, s27, 2
    s_add_u32 s43, s43, 78464
    v_mov_b32 v27, s43
    s_lshl_b32 s43, s26, 2
    s_add_u32 s43, s43, 80000
    v_mov_b32 v29, s43
    s_xor_b32 s43, s43, 4
    v_mov_b32 v30, s43
    v_mov_b32 v31, 0
    ds_write_b32 v29, v31
    v_lshlrev_b32 v24, 5, v7
    v_lshrrev_b32 v60, 1, v2
    v_lshl_add_u32 v24, v60, 4, v24
    v_and_b32 v60, 1, v2
    v_lshl_add_u32 v24, v60, 9, v24
    v_mov_b32 v96, 0
    v_mov_b32 v97, 0
    v_mov_b32 v98, 0
    v_mov_b32 v99, 0
    v_mov_b32 v100, 0
    v_mov_b32 v101, 0
    v_mov_b32 v102, 0
    v_mov_b32 v103, 0
    v_mov_b32 v104, 0
    v_mov_b32 v105, 0
    v_mov_b32 v106, 0
    v_mov_b32 v107, 0
    v_mov_b32 v108, 0
    v_mov_b32 v109, 0
    v_mov_b32 v110, 0
    v_mov_b32 v111, 0
    v_mov_b32 v112, 0
    v_mov_b32 v113, 0
    v_mov_b32 v114, 0
    v_mov_b32 v115, 0
    v_mov_b32 v116, 0
    v_mov_b32 v117, 0
    v_mov_b32 v118, 0
    v_mov_b32 v119, 0
    v_mov_b32 v120, 0
    v_mov_b32 v121, 0
    v_mov_b32 v122, 0
    v_mov_b32 v123, 0
    v_mov_b32 v124, 0
    v_mov_b32 v125, 0
    v_mov_b32 v126, 0
    v_mov_b32 v127, 0
    v_mov_b32 v36, 80036
    v_mov_b32 v37, 1
    s_mov_b64 exec, 1
    ds_add_u32 v36, v37
    s_mov_b64 exec, -1
    v_add_u32 v11, 0, v0
    v_lshrrev_b32 v12, 1, v11
    v_and_b32 v10, 1, v11
    v_lshlrev_b32 v4, 13, v12
    v_lshl_add_u32 v4, v10, 4, v4
    s_lshl_b32 s38, s29, 4
    s_add_u32 s38, s38, 1048576
    v_add_u32 v4, s38, v4
    v_lshlrev_b32 v5, 5, v12
    v_add_u32 v5, 16384, v5
    s_lshr_b32 s38, s29, 4
    s_lshl_b32 s38, s38, 7
    s_and_b32 s39, s29, 15
    s_lshl_b32 s39, s39, 2
    s_add_u32 s38, s38, s39
    s_add_u32 s38, s38, 65536
    v_lshl_add_u32 v6, v10, 2, s38
    v_mul_u32_u24 v7, 4608, v10
    v_lshl_add_u32 v7, v12, 4, v7
    v_add_u32 v7, 33792, v7
    v_lshlrev_b32 v8, 12, v10
    v_lshl_add_u32 v8, v12, 4, v8
    v_add_u32 v8, 42496, v8
    v_lshlrev_b32 v9, 2, v10
    v_add_u32 v9, 78464, v9
    v_add_u32 v13, 4096, v6
    v_add_u32 v14, 4096, v13
    v_mov_b32 v36, 80036
lw_k3:
    ds_read_b32 v37, v36
    s_waitcnt lgkmcnt(0)
    v_readfirstlane_b32 s62, v37
    s_cmp_ge_u32 s62, 4
    s_cbranch_scc1 lw_k3_done
    s_sleep 1
    s_branch lw_k3
lw_k3_done:
    ds_read_b64 v[32:33], v20 offset:3776
    ds_read_b64 v[34:35], v20 offset:3784
    ds_read_b64 v[36:37], v20 offset:3264
    ds_read_b64 v[38:39], v20 offset:3272
    ds_read_b64 v[40:41], v20 offset:2752
    ds_read_b64 v[42:43], v20 offset:2760
    ds_read_b64 v[44:45], v20 offset:2240
    ds_read_b64 v[46:47], v20 offset:2248
    ds_read_b64 v[48:49], v20 offset:1728
    ds_read_b64 v[50:51], v20 offset:1736
    ds_read_b64 v[52:53], v20 offset:1216
    ds_read_b64 v[54:55], v20 offset:1224
    ds_read_b64 v[56:57], v20 offset:704
    ds_read_b64 v[58:59], v20 offset:712
    ds_read_b64 v[60:61], v20 offset:192
    ds_read_b64 v[62:63], v20 offset:200
    s_cmp_eq_u32 s26, 0
    s_cbranch_scc0 k_waitrel
    v_mov_b32 v16, 80040
lw_k6:
    ds_read_b32 v17, v16
    s_waitcnt lgkmcnt(0)
    v_readfirstlane_b32 s62, v17
    s_cmp_ge_u32 s62, 1
    s_cbranch_scc1 lw_k6_done
    s_sleep 1
    s_branch lw_k6
lw_k6_done:
    s_lshr_b32 s34, s2, 3
    s_and_b32 s34, s34, 15
    s_lshl_b32 s34, s34, 7
    s_add_u32 s34, s34, 188416
    v_and_b32 v80, 7, v1
    v_lshl_add_u32 v80, v80, 11, s34
    v_mov_b32 v81, 0
    s_mov_b32 s60, 0
k_poll:
    s_mov_b64 exec, 0xff
    global_atomic_add v82, v80, v81, s[22:23] sc0 sc1
    s_waitcnt vmcnt(0)
    v_cmp_ne_u32 vcc, 32, v82
    s_mov_b64 exec, -1
    s_cbranch_vccz k_go
    s_add_u32 s60, s60, 1
    s_sleep 1
    s_cmp_lt_u32 s60, 131072
    s_cbranch_scc1 k_poll
k_go:
    v_mov_b32 v16, 80032
    v_mov_b32 v17, 1
    s_mov_b64 exec, 1
    ds_add_u32 v16, v17
    s_mov_b64 exec, -1
k_waitrel:
    v_mov_b32 v16, 80032
lw_k4:
    ds_read_b32 v17, v16
    s_waitcnt lgkmcnt(0)
    v_readfirstlane_b32 s62, v17
    s_cmp_ge_u32 s62, 1
    s_cbranch_scc1 lw_k4_done
    s_sleep 1
    s_branch lw_k4
lw_k4_done:
    global_load_dwordx4 v[64:67], v4, s[22:23] sc1
    global_load_dwordx4 v[68:71], v5, s[22:23] sc1
    global_load_dwordx4 v[72:75], v5, s[22:23] offset:16 sc1
    global_load_dword v76, v6, s[22:23] sc1
    global_load_dword v77, v13, s[22:23] sc1
    global_load_dword v78, v14, s[22:23] sc1
    s_waitcnt vmcnt(5)
    ds_write_b128 v8, v[64:67]
    v_lshlrev_b32 v80, 16, v64
    v_and_b32 v81, 0xffff0000, v64
    v_lshlrev_b32 v82, 16, v65
    v_and_b32 v83, 0xffff0000, v65
    v_lshlrev_b32 v84, 16, v66
    v_and_b32 v85, 0xffff0000, v66
    v_lshlrev_b32 v86, 16, v67
    v_and_b32 v87, 0xffff0000, v67
    s_waitcnt vmcnt(3)
    v_lshlrev_b32 v12, 16, v68
    v_and_b32 v68, 0xffff0000, v68
    v_fma_f32 v80, v80, v12, v68
    v_lshlrev_b32 v13, 16, v69
    v_and_b32 v69, 0xffff0000, v69
    v_fma_f32 v81, v81, v13, v69
    v_lshlrev_b32 v14, 16, v70
    v_and_b32 v70, 0xffff0000, v70
    v_fma_f32 v82, v82, v14, v70
    v_lshlrev_b32 v15, 16, v71
    v_and_b32 v71, 0xffff0000, v71
    v_fma_f32 v83, v83, v15, v71
    v_lshlrev_b32 v12, 16, v72
    v_and_b32 v72, 0xffff0000, v72
    v_fma_f32 v84, v84, v12, v72
    v_lshlrev_b32 v13, 16, v73
    v_and_b32 v73, 0xffff0000, v73
    v_fma_f32 v85, v85, v13, v73
    v_lshlrev_b32 v14, 16, v74
    v_and_b32 v74, 0xffff0000, v74
    v_fma_f32 v86, v86, v14, v74
    v_lshlrev_b32 v15, 16, v75
    v_and_b32 v75, 0xffff0000, v75
    v_fma_f32 v87, v87, v15, v75
    s_waitcnt vmcnt(0)
    v_add_f32 v77, 1.0, v77
    v_cvt_pk_bf16_f32 v77, v77, v77
    ds_write_b32 v9, v78
    v_lshlrev_b32 v77, 16, v77
    v_fma_f32 v80, v80, v77, v76
    v_fma_f32 v81, v81, v77, v76
    v_fma_f32 v82, v82, v77, v76
    v_fma_f32 v83, v83, v77, v76
    v_fma_f32 v84, v84, v77, v76
    v_fma_f32 v85, v85, v77, v76
    v_fma_f32 v86, v86, v77, v76
    v_fma_f32 v87, v87, v77, v76
    v_cvt_pk_bf16_f32 v88, v80, v81
    v_cvt_pk_bf16_f32 v89, v82, v83
    v_cvt_pk_bf16_f32 v90, v84, v85
    v_cvt_pk_bf16_f32 v91, v86, v87
    ds_write_b128 v7, v[88:91]
    s_waitcnt lgkmcnt(0)
    s_barrier
    ds_read_b128 v[92:95], v21 offset:3776
    ds_read_b128 v[88:91], v21 offset:3264
    ds_read_b128 v[84:87], v21 offset:2752
    ds_read_b128 v[80:83], v21 offset:2240
    ds_read_b128 v[76:79], v21 offset:1728
    ds_read_b128 v[72:75], v21 offset:1216
    ds_read_b128 v[68:71], v21 offset:704
    ds_read_b128 v[64:67], v21 offset:192
    ds_read_b32 v28, v27
    s_waitcnt lgkmcnt(8)
    v_mfma_f32_16x16x32_bf16 v[124:127], v[32:35], v[92:95], v[124:127]
    ds_read_b128 v[92:95], v21 offset:3712
    s_waitcnt lgkmcnt(8)
    v_mfma_f32_16x16x32_bf16 v[120:123], v[32:35], v[88:91], v[120:123]
    s_waitcnt lgkmcnt(7)
    v_mfma_f32_16x16x32_bf16 v[116:119], v[32:35], v[84:87], v[116:119]
    s_waitcnt lgkmcnt(6)
    v_mfma_f32_16x16x32_bf16 v[112:115], v[32:35], v[80:83], v[112:115]
    s_waitcnt lgkmcnt(5)
    v_mfma_f32_16x16x32_bf16 v[108:111], v[32:35], v[76:79], v[108:111]
    s_waitcnt lgkmcnt(4)
    v_mfma_f32_16x16x32_bf16 v[104:107], v[32:35], v[72:75], v[104:107]
    s_waitcnt lgkmcnt(3)
    v_mfma_f32_16x16x32_bf16 v[100:103], v[32:35], v[68:71], v[100:103]
    s_waitcnt lgkmcnt(2)
    v_mfma_f32_16x16x32_bf16 v[96:99], v[32:35], v[64:67], v[96:99]
    ds_read_b64 v[32:33], v20 offset:3712
    ds_read_b64 v[34:35], v20 offset:3720
    v_mfma_f32_16x16x32_bf16 v[124:127], v[36:39], v[88:91], v[124:127]
    ds_read_b128 v[88:91], v21 offset:3200
    v_mfma_f32_16x16x32_bf16 v[120:123], v[36:39], v[84:87], v[120:123]
    v_mfma_f32_16x16x32_bf16 v[116:119], v[36:39], v[80:83], v[116:119]
    v_mfma_f32_16x16x32_bf16 v[112:115], v[36:39], v[76:79], v[112:115]
    v_mfma_f32_16x16x32_bf16 v[108:111], v[36:39], v[72:75], v[108:111]
    v_mfma_f32_16x16x32_bf16 v[104:107], v[36:39], v[68:71], v[104:107]
    v_mfma_f32_16x16x32_bf16 v[100:103], v[36:39], v[64:67], v[100:103]
    ds_read_b64 v[36:37], v20 offset:3200
    ds_read_b64 v[38:39], v20 offset:3208
    v_mfma_f32_16x16x32_bf16 v[124:127], v[40:43], v[84:87], v[124:127]
    ds_read_b128 v[84:87], v21 offset:2688
    v_mfma_f32_16x16x32_bf16 v[120:123], v[40:43], v[80:83], v[120:123]
    v_mfma_f32_16x16x32_bf16 v[116:119], v[40:43], v[76:79], v[116:119]
    v_mfma_f32_16x16x32_bf16 v[112:115], v[40:43], v[72:75], v[112:115]
    v_mfma_f32_16x16x32_bf16 v[108:111], v[40:43], v[68:71], v[108:111]
    v_mfma_f32_16x16x32_bf16 v[104:107], v[40:43], v[64:67], v[104:107]
    ds_read_b64 v[40:41], v20 offset:2688
    ds_read_b64 v[42:43], v20 offset:2696
    v_mfma_f32_16x16x32_bf16 v[124:127], v[44:47], v[80:83], v[124:127]
    ds_read_b128 v[80:83], v21 offset:2176
    v_mfma_f32_16x16x32_bf16 v[120:123], v[44:47], v[76:79], v[120:123]
    v_mfma_f32_16x16x32_bf16 v[116:119], v[44:47], v[72:75], v[116:119]
    v_mfma_f32_16x16x32_bf16 v[112:115], v[44:47], v[68:71], v[112:115]
    v_mfma_f32_16x16x32_bf16 v[108:111], v[44:47], v[64:67], v[108:111]
    ds_read_b64 v[44:45], v20 offset:2176
    ds_read_b64 v[46:47], v20 offset:2184
    v_mfma_f32_16x16x32_bf16 v[124:127], v[48:51], v[76:79], v[124:127]
    ds_read_b128 v[76:79], v21 offset:1664
    v_mfma_f32_16x16x32_bf16 v[120:123], v[48:51], v[72:75], v[120:123]
    v_mfma_f32_16x16x32_bf16 v[116:119], v[48:51], v[68:71], v[116:119]
    v_mfma_f32_16x16x32_bf16 v[112:115], v[48:51], v[64:67], v[112:115]
    ds_read_b64 v[48:49], v20 offset:1664
    ds_read_b64 v[50:51], v20 offset:1672
    v_mfma_f32_16x16x32_bf16 v[124:127], v[52:55], v[72:75], v[124:127]
    ds_read_b128 v[72:75], v21 offset:1152
    v_mfma_f32_16x16x32_bf16 v[120:123], v[52:55], v[68:71], v[120:123]
    v_mfma_f32_16x16x32_bf16 v[116:119], v[52:55], v[64:67], v[116:119]
    ds_read_b64 v[52:53], v20 offset:1152
    ds_read_b64 v[54:55], v20 offset:1160
    v_mfma_f32_16x16x32_bf16 v[124:127], v[56:59], v[68:71], v[124:127]
    ds_read_b128 v[68:71], v21 offset:640
    v_mfma_f32_16x16x32_bf16 v[120:123], v[56:59], v[64:67], v[120:123]
    ds_read_b64 v[56:57], v20 offset:640
    ds_read_b64 v[58:59], v20 offset:648
    v_mfma_f32_16x16x32_bf16 v[124:127], v[60:63], v[64:67], v[124:127]
    ds_read_b128 v[64:67], v21 offset:128
    ds_read_b64 v[60:61], v20 offset:128
    ds_read_b64 v[62:63], v20 offset:136
    s_waitcnt lgkmcnt(15)
    v_mfma_f32_16x16x32_bf16 v[124:127], v[32:35], v[92:95], v[124:127]
    ds_read_b128 v[92:95], v21 offset:3648
    v_mfma_f32_16x16x32_bf16 v[120:123], v[32:35], v[88:91], v[120:123]
    v_mfma_f32_16x16x32_bf16 v[116:119], v[32:35], v[84:87], v[116:119]
    s_waitcnt lgkmcnt(15)
    v_mfma_f32_16x16x32_bf16 v[112:115], v[32:35], v[80:83], v[112:115]
    s_waitcnt lgkmcnt(12)
    v_mfma_f32_16x16x32_bf16 v[108:111], v[32:35], v[76:79], v[108:111]
    s_waitcnt lgkmcnt(9)
    v_mfma_f32_16x16x32_bf16 v[104:107], v[32:35], v[72:75], v[104:107]
    s_waitcnt lgkmcnt(6)
    v_mfma_f32_16x16x32_bf16 v[100:103], v[32:35], v[68:71], v[100:103]
    s_waitcnt lgkmcnt(3)
    v_mfma_f32_16x16x32_bf16 v[96:99], v[32:35], v[64:67], v[96:99]
    ds_read_b64 v[32:33], v20 offset:3648
    ds_read_b64 v[34:35], v20 offset:3656
    v_mfma_f32_16x16x32_bf16 v[124:127], v[36:39], v[88:91], v[124:127]
    ds_read_b128 v[88:91], v21 offset:3136
    v_mfma_f32_16x16x32_bf16 v[120:123], v[36:39], v[84:87], v[120:123]
    v_mfma_f32_16x16x32_bf16 v[116:119], v[36:39], v[80:83], v[116:119]
    v_mfma_f32_16x16x32_bf16 v[112:115], v[36:39], v[76:79], v[112:115]
    v_mfma_f32_16x16x32_bf16 v[108:111], v[36:39], v[72:75], v[108:111]
    v_mfma_f32_16x16x32_bf16 v[104:107], v[36:39], v[68:71], v[104:107]
    v_mfma_f32_16x16x32_bf16 v[100:103], v[36:39], v[64:67], v[100:103]
    ds_read_b64 v[36:37], v20 offset:3136
    ds_read_b64 v[38:39], v20 offset:3144
    v_mfma_f32_16x16x32_bf16 v[124:127], v[40:43], v[84:87], v[124:127]
    ds_read_b128 v[84:87], v21 offset:2624
    v_mfma_f32_16x16x32_bf16 v[120:123], v[40:43], v[80:83], v[120:123]
    v_mfma_f32_16x16x32_bf16 v[116:119], v[40:43], v[76:79], v[116:119]
    v_mfma_f32_16x16x32_bf16 v[112:115], v[40:43], v[72:75], v[112:115]
    v_mfma_f32_16x16x32_bf16 v[108:111], v[40:43], v[68:71], v[108:111]
    v_mfma_f32_16x16x32_bf16 v[104:107], v[40:43], v[64:67], v[104:107]
    ds_read_b64 v[40:41], v20 offset:2624
    ds_read_b64 v[42:43], v20 offset:2632
    v_mfma_f32_16x16x32_bf16 v[124:127], v[44:47], v[80:83], v[124:127]
    ds_read_b128 v[80:83], v21 offset:2112
    v_mfma_f32_16x16x32_bf16 v[120:123], v[44:47], v[76:79], v[120:123]
    v_mfma_f32_16x16x32_bf16 v[116:119], v[44:47], v[72:75], v[116:119]
    v_mfma_f32_16x16x32_bf16 v[112:115], v[44:47], v[68:71], v[112:115]
    v_mfma_f32_16x16x32_bf16 v[108:111], v[44:47], v[64:67], v[108:111]
    ds_read_b64 v[44:45], v20 offset:2112
    ds_read_b64 v[46:47], v20 offset:2120
    v_mfma_f32_16x16x32_bf16 v[124:127], v[48:51], v[76:79], v[124:127]
    ds_read_b128 v[76:79], v21 offset:1600
    v_mfma_f32_16x16x32_bf16 v[120:123], v[48:51], v[72:75], v[120:123]
    v_mfma_f32_16x16x32_bf16 v[116:119], v[48:51], v[68:71], v[116:119]
    v_mfma_f32_16x16x32_bf16 v[112:115], v[48:51], v[64:67], v[112:115]
    ds_read_b64 v[48:49], v20 offset:1600
    ds_read_b64 v[50:51], v20 offset:1608
    v_mfma_f32_16x16x32_bf16 v[124:127], v[52:55], v[72:75], v[124:127]
    ds_read_b128 v[72:75], v21 offset:1088
    v_mfma_f32_16x16x32_bf16 v[120:123], v[52:55], v[68:71], v[120:123]
    v_mfma_f32_16x16x32_bf16 v[116:119], v[52:55], v[64:67], v[116:119]
    ds_read_b64 v[52:53], v20 offset:1088
    ds_read_b64 v[54:55], v20 offset:1096
    v_mfma_f32_16x16x32_bf16 v[124:127], v[56:59], v[68:71], v[124:127]
    ds_read_b128 v[68:71], v21 offset:576
    v_mfma_f32_16x16x32_bf16 v[120:123], v[56:59], v[64:67], v[120:123]
    ds_read_b64 v[56:57], v20 offset:576
    ds_read_b64 v[58:59], v20 offset:584
    s_waitcnt lgkmcnt(15)
    v_mfma_f32_16x16x32_bf16 v[124:127], v[60:63], v[64:67], v[124:127]
    ds_read_b128 v[64:67], v21 offset:64
    ds_read_b64 v[60:61], v20 offset:64
    ds_read_b64 v[62:63], v20 offset:72
    v_mfma_f32_16x16x32_bf16 v[124:127], v[32:35], v[92:95], v[124:127]
    ds_read_b128 v[92:95], v21 offset:3584
    v_mfma_f32_16x16x32_bf16 v[120:123], v[32:35], v[88:91], v[120:123]
    s_waitcnt lgkmcnt(15)
    v_mfma_f32_16x16x32_bf16 v[116:119], v[32:35], v[84:87], v[116:119]
    v_mfma_f32_16x16x32_bf16 v[112:115], v[32:35], v[80:83], v[112:115]
    s_waitcnt lgkmcnt(12)
    v_mfma_f32_16x16x32_bf16 v[108:111], v[32:35], v[76:79], v[108:111]
    s_waitcnt lgkmcnt(9)
    v_mfma_f32_16x16x32_bf16 v[104:107], v[32:35], v[72:75], v[104:107]
    s_waitcnt lgkmcnt(6)
    v_mfma_f32_16x16x32_bf16 v[100:103], v[32:35], v[68:71], v[100:103]
    s_waitcnt lgkmcnt(3)
    v_mfma_f32_16x16x32_bf16 v[96:99], v[32:35], v[64:67], v[96:99]
    ds_read_b64 v[32:33], v20 offset:3584
    ds_read_b64 v[34:35], v20 offset:3592
    v_mfma_f32_16x16x32_bf16 v[124:127], v[36:39], v[88:91], v[124:127]
    ds_read_b128 v[88:91], v21 offset:3072
    v_mfma_f32_16x16x32_bf16 v[120:123], v[36:39], v[84:87], v[120:123]
    v_mfma_f32_16x16x32_bf16 v[116:119], v[36:39], v[80:83], v[116:119]
    v_mfma_f32_16x16x32_bf16 v[112:115], v[36:39], v[76:79], v[112:115]
    v_mfma_f32_16x16x32_bf16 v[108:111], v[36:39], v[72:75], v[108:111]
    v_mfma_f32_16x16x32_bf16 v[104:107], v[36:39], v[68:71], v[104:107]
    v_mfma_f32_16x16x32_bf16 v[100:103], v[36:39], v[64:67], v[100:103]
    ds_read_b64 v[36:37], v20 offset:3072
    ds_read_b64 v[38:39], v20 offset:3080
    v_mfma_f32_16x16x32_bf16 v[124:127], v[40:43], v[84:87], v[124:127]
    ds_read_b128 v[84:87], v21 offset:2560
    v_mfma_f32_16x16x32_bf16 v[120:123], v[40:43], v[80:83], v[120:123]
    v_mfma_f32_16x16x32_bf16 v[116:119], v[40:43], v[76:79], v[116:119]
    v_mfma_f32_16x16x32_bf16 v[112:115], v[40:43], v[72:75], v[112:115]
    v_mfma_f32_16x16x32_bf16 v[108:111], v[40:43], v[68:71], v[108:111]
    v_mfma_f32_16x16x32_bf16 v[104:107], v[40:43], v[64:67], v[104:107]
    ds_read_b64 v[40:41], v20 offset:2560
    ds_read_b64 v[42:43], v20 offset:2568
    v_mfma_f32_16x16x32_bf16 v[124:127], v[44:47], v[80:83], v[124:127]
    ds_read_b128 v[80:83], v21 offset:2048
    v_mfma_f32_16x16x32_bf16 v[120:123], v[44:47], v[76:79], v[120:123]
    v_mfma_f32_16x16x32_bf16 v[116:119], v[44:47], v[72:75], v[116:119]
    v_mfma_f32_16x16x32_bf16 v[112:115], v[44:47], v[68:71], v[112:115]
    v_mfma_f32_16x16x32_bf16 v[108:111], v[44:47], v[64:67], v[108:111]
    ds_read_b64 v[44:45], v20 offset:2048
    ds_read_b64 v[46:47], v20 offset:2056
    v_mfma_f32_16x16x32_bf16 v[124:127], v[48:51], v[76:79], v[124:127]
    ds_read_b128 v[76:79], v21 offset:1536
    v_mfma_f32_16x16x32_bf16 v[120:123], v[48:51], v[72:75], v[120:123]
    v_mfma_f32_16x16x32_bf16 v[116:119], v[48:51], v[68:71], v[116:119]
    v_mfma_f32_16x16x32_bf16 v[112:115], v[48:51], v[64:67], v[112:115]
    ds_read_b64 v[48:49], v20 offset:1536
    ds_read_b64 v[50:51], v20 offset:1544
    v_mfma_f32_16x16x32_bf16 v[124:127], v[52:55], v[72:75], v[124:127]
    ds_read_b128 v[72:75], v21 offset:1024
    v_mfma_f32_16x16x32_bf16 v[120:123], v[52:55], v[68:71], v[120:123]
    v_mfma_f32_16x16x32_bf16 v[116:119], v[52:55], v[64:67], v[116:119]
    ds_read_b64 v[52:53], v20 offset:1024
    ds_read_b64 v[54:55], v20 offset:1032
    v_mfma_f32_16x16x32_bf16 v[124:127], v[56:59], v[68:71], v[124:127]
    ds_read_b128 v[68:71], v21 offset:512
    v_mfma_f32_16x16x32_bf16 v[120:123], v[56:59], v[64:67], v[120:123]
    ds_read_b64 v[56:57], v20 offset:512
    ds_read_b64 v[58:59], v20 offset:520
    s_waitcnt lgkmcnt(15)
    v_mfma_f32_16x16x32_bf16 v[124:127], v[60:63], v[64:67], v[124:127]
    ds_read_b128 v[64:67], v21 offset:0
    ds_read_b64 v[60:61], v20 offset:0
    ds_read_b64 v[62:63], v20 offset:8
    v_mfma_f32_16x16x32_bf16 v[124:127], v[32:35], v[92:95], v[124:127]
    v_mfma_f32_16x16x32_bf16 v[120:123], v[32:35], v[88:91], v[120:123]
    s_waitcnt lgkmcnt(15)
    v_mfma_f32_16x16x32_bf16 v[116:119], v[32:35], v[84:87], v[116:119]
    s_waitcnt lgkmcnt(14)
    v_mfma_f32_16x16x32_bf16 v[112:115], v[32:35], v[80:83], v[112:115]
    s_waitcnt lgkmcnt(11)
    v_mfma_f32_16x16x32_bf16 v[108:111], v[32:35], v[76:79], v[108:111]
    s_waitcnt lgkmcnt(8)
    v_mfma_f32_16x16x32_bf16 v[104:107], v[32:35], v[72:75], v[104:107]
    s_waitcnt lgkmcnt(5)
    v_mfma_f32_16x16x32_bf16 v[100:103], v[32:35], v[68:71], v[100:103]
    s_waitcnt lgkmcnt(2)
    v_mfma_f32_16x16x32_bf16 v[96:99], v[32:35], v[64:67], v[96:99]
    v_mfma_f32_16x16x32_bf16 v[124:127], v[36:39], v[88:91], v[124:127]
    v_mfma_f32_16x16x32_bf16 v[120:123], v[36:39], v[84:87], v[120:123]
    v_mfma_f32_16x16x32_bf16 v[116:119], v[36:39], v[80:83], v[116:119]
    v_mfma_f32_16x16x32_bf16 v[112:115], v[36:39], v[76:79], v[112:115]
    v_mfma_f32_16x16x32_bf16 v[108:111], v[36:39], v[72:75], v[108:111]
    v_mfma_f32_16x16x32_bf16 v[104:107], v[36:39], v[68:71], v[104:107]
    v_mfma_f32_16x16x32_bf16 v[100:103], v[36:39], v[64:67], v[100:103]
    v_mfma_f32_16x16x32_bf16 v[124:127], v[40:43], v[84:87], v[124:127]
    v_mfma_f32_16x16x32_bf16 v[120:123], v[40:43], v[80:83], v[120:123]
    v_mfma_f32_16x16x32_bf16 v[116:119], v[40:43], v[76:79], v[116:119]
    v_mfma_f32_16x16x32_bf16 v[112:115], v[40:43], v[72:75], v[112:115]
    v_mfma_f32_16x16x32_bf16 v[108:111], v[40:43], v[68:71], v[108:111]
    v_mfma_f32_16x16x32_bf16 v[104:107], v[40:43], v[64:67], v[104:107]
    v_mfma_f32_16x16x32_bf16 v[124:127], v[44:47], v[80:83], v[124:127]
    v_mfma_f32_16x16x32_bf16 v[120:123], v[44:47], v[76:79], v[120:123]
    v_mfma_f32_16x16x32_bf16 v[116:119], v[44:47], v[72:75], v[116:119]
    v_mfma_f32_16x16x32_bf16 v[112:115], v[44:47], v[68:71], v[112:115]
    v_mfma_f32_16x16x32_bf16 v[108:111], v[44:47], v[64:67], v[108:111]
    v_mfma_f32_16x16x32_bf16 v[124:127], v[48:51], v[76:79], v[124:127]
    v_mfma_f32_16x16x32_bf16 v[120:123], v[48:51], v[72:75], v[120:123]
    v_mfma_f32_16x16x32_bf16 v[116:119], v[48:51], v[68:71], v[116:119]
    v_mfma_f32_16x16x32_bf16 v[112:115], v[48:51], v[64:67], v[112:115]
    ds_read_b64 v[4:5], v23 offset:0
    ds_read_b64 v[6:7], v23 offset:512
    ds_read_b64 v[8:9], v23 offset:1024
    ds_read_b64 v[10:11], v23 offset:1536
    v_mfma_f32_16x16x32_bf16 v[124:127], v[52:55], v[72:75], v[124:127]
    v_mfma_f32_16x16x32_bf16 v[120:123], v[52:55], v[68:71], v[120:123]
    v_mfma_f32_16x16x32_bf16 v[116:119], v[52:55], v[64:67], v[116:119]
    v_mfma_f32_16x16x32_bf16 v[124:127], v[56:59], v[68:71], v[124:127]
    v_mfma_f32_16x16x32_bf16 v[120:123], v[56:59], v[64:67], v[120:123]
    s_waitcnt lgkmcnt(4)
    v_mfma_f32_16x16x32_bf16 v[124:127], v[60:63], v[64:67], v[124:127]
    s_waitcnt lgkmcnt(0)
    v_lshlrev_b32 v32, 16, v4
    v_and_b32 v33, 0xffff0000, v4
    v_lshlrev_b32 v34, 16, v5
    v_and_b32 v35, 0xffff0000, v5
    v_lshlrev_b32 v36, 16, v6
    v_and_b32 v37, 0xffff0000, v6
    v_lshlrev_b32 v38, 16, v7
    v_and_b32 v39, 0xffff0000, v7
    v_lshlrev_b32 v40, 16, v8
    v_and_b32 v41, 0xffff0000, v8
    v_lshlrev_b32 v42, 16, v9
    v_and_b32 v43, 0xffff0000, v9
    v_lshlrev_b32 v44, 16, v10
    v_and_b32 v45, 0xffff0000, v10
    v_lshlrev_b32 v46, 16, v11
    v_and_b32 v47, 0xffff0000, v11
    s_cmp_eq_u32 s28, 1
    s_cbranch_scc1 k_hf1
    ds_write_b128 v25, v[112:115] offset:0
    ds_write_b128 v25, v[116:119] offset:1024
    ds_write_b128 v25, v[120:123] offset:2048
    ds_write_b128 v25, v[124:127] offset:3072
    v_mov_b32 v31, 1
    ds_write_b32 v29, v31
    v_fma_f32 v32, v28, v96, v32
    v_fma_f32 v33, v28, v97, v33
    v_fma_f32 v34, v28, v98, v34
    v_fma_f32 v35, v28, v99, v35
    v_fma_f32 v36, v28, v100, v36
    v_fma_f32 v37, v28, v101, v37
    v_fma_f32 v38, v28, v102, v38
    v_fma_f32 v39, v28, v103, v39
    v_fma_f32 v40, v28, v104, v40
    v_fma_f32 v41, v28, v105, v41
    v_fma_f32 v42, v28, v106, v42
    v_fma_f32 v43, v28, v107, v43
    v_fma_f32 v44, v28, v108, v44
    v_fma_f32 v45, v28, v109, v45
    v_fma_f32 v46, v28, v110, v46
    v_fma_f32 v47, v28, v111, v47
k_hs0:
    ds_read_b32 v31, v30
    s_waitcnt lgkmcnt(0)
    v_readfirstlane_b32 s43, v31
    s_cmp_eq_u32 s43, 1
    s_cbranch_scc0 k_hs0
    ds_read_b128 v[64:67], v26 offset:0
    ds_read_b128 v[68:71], v26 offset:1024
    ds_read_b128 v[72:75], v26 offset:2048
    ds_read_b128 v[76:79], v26 offset:3072
    s_waitcnt lgkmcnt(3)
    v_fma_f32 v32, v28, v64, v32
    v_fma_f32 v33, v28, v65, v33
    v_fma_f32 v34, v28, v66, v34
    v_fma_f32 v35, v28, v67, v35
    v_cvt_pk_bf16_f32 v12, v32, v33
    v_cvt_pk_bf16_f32 v13, v34, v35
    s_waitcnt lgkmcnt(2)
    v_fma_f32 v36, v28, v68, v36
    v_fma_f32 v37, v28, v69, v37
    v_fma_f32 v38, v28, v70, v38
    v_fma_f32 v39, v28, v71, v39
    v_cvt_pk_bf16_f32 v14, v36, v37
    v_cvt_pk_bf16_f32 v15, v38, v39
    s_nop 1
    v_permlane16_swap_b32 v12, v14
    v_permlane16_swap_b32 v13, v15
    global_store_dwordx4 v24, v[12:15], s[50:51] offset:0 sc1
    s_waitcnt lgkmcnt(1)
    v_fma_f32 v40, v28, v72, v40
    v_fma_f32 v41, v28, v73, v41
    v_fma_f32 v42, v28, v74, v42
    v_fma_f32 v43, v28, v75, v43
    v_cvt_pk_bf16_f32 v16, v40, v41
    v_cvt_pk_bf16_f32 v17, v42, v43
    s_waitcnt lgkmcnt(0)
    v_fma_f32 v44, v28, v76, v44
    v_fma_f32 v45, v28, v77, v45
    v_fma_f32 v46, v28, v78, v46
    v_fma_f32 v47, v28, v79, v47
    v_cvt_pk_bf16_f32 v18, v44, v45
    v_cvt_pk_bf16_f32 v19, v46, v47
    s_nop 1
    v_permlane16_swap_b32 v16, v18
    v_permlane16_swap_b32 v17, v19
    global_store_dwordx4 v24, v[16:19], s[50:51] offset:1024 sc1
    s_waitcnt vmcnt(0)
    s_branch mega_next
k_hf1:
    ds_write_b128 v25, v[96:99] offset:0
    ds_write_b128 v25, v[100:103] offset:1024
    ds_write_b128 v25, v[104:107] offset:2048
    ds_write_b128 v25, v[108:111] offset:3072
    v_mov_b32 v31, 1
    ds_write_b32 v29, v31
    v_fma_f32 v32, v28, v112, v32
    v_fma_f32 v33, v28, v113, v33
    v_fma_f32 v34, v28, v114, v34
    v_fma_f32 v35, v28, v115, v35
    v_fma_f32 v36, v28, v116, v36
    v_fma_f32 v37, v28, v117, v37
    v_fma_f32 v38, v28, v118, v38
    v_fma_f32 v39, v28, v119, v39
    v_fma_f32 v40, v28, v120, v40
    v_fma_f32 v41, v28, v121, v41
    v_fma_f32 v42, v28, v122, v42
    v_fma_f32 v43, v28, v123, v43
    v_fma_f32 v44, v28, v124, v44
    v_fma_f32 v45, v28, v125, v45
    v_fma_f32 v46, v28, v126, v46
    v_fma_f32 v47, v28, v127, v47
k_hs1:
    ds_read_b32 v31, v30
    s_waitcnt lgkmcnt(0)
    v_readfirstlane_b32 s43, v31
    s_cmp_eq_u32 s43, 1
    s_cbranch_scc0 k_hs1
    ds_read_b128 v[64:67], v26 offset:0
    ds_read_b128 v[68:71], v26 offset:1024
    ds_read_b128 v[72:75], v26 offset:2048
    ds_read_b128 v[76:79], v26 offset:3072
    s_waitcnt lgkmcnt(3)
    v_fma_f32 v32, v28, v64, v32
    v_fma_f32 v33, v28, v65, v33
    v_fma_f32 v34, v28, v66, v34
    v_fma_f32 v35, v28, v67, v35
    v_cvt_pk_bf16_f32 v12, v32, v33
    v_cvt_pk_bf16_f32 v13, v34, v35
    s_waitcnt lgkmcnt(2)
    v_fma_f32 v36, v28, v68, v36
    v_fma_f32 v37, v28, v69, v37
    v_fma_f32 v38, v28, v70, v38
    v_fma_f32 v39, v28, v71, v39
    v_cvt_pk_bf16_f32 v14, v36, v37
    v_cvt_pk_bf16_f32 v15, v38, v39
    s_nop 1
    v_permlane16_swap_b32 v12, v14
    v_permlane16_swap_b32 v13, v15
    global_store_dwordx4 v24, v[12:15], s[50:51] offset:0 sc1
    s_waitcnt lgkmcnt(1)
    v_fma_f32 v40, v28, v72, v40
    v_fma_f32 v41, v28, v73, v41
    v_fma_f32 v42, v28, v74, v42
    v_fma_f32 v43, v28, v75, v43
    v_cvt_pk_bf16_f32 v16, v40, v41
    v_cvt_pk_bf16_f32 v17, v42, v43
    s_waitcnt lgkmcnt(0)
    v_fma_f32 v44, v28, v76, v44
    v_fma_f32 v45, v28, v77, v45
    v_fma_f32 v46, v28, v78, v46
    v_fma_f32 v47, v28, v79, v47
    v_cvt_pk_bf16_f32 v18, v44, v45
    v_cvt_pk_bf16_f32 v19, v46, v47
    s_nop 1
    v_permlane16_swap_b32 v16, v18
    v_permlane16_swap_b32 v17, v19
    global_store_dwordx4 v24, v[16:19], s[50:51] offset:1024 sc1
    s_waitcnt vmcnt(0)
    s_branch mega_next
mega_next:
    s_setprio 0
    v_lshrrev_b32 v28, 6, v0
    s_and_b32 s12, s2, 7
    v_readfirstlane_b32 s13, v28
    s_lshl_b32 s12, s12, 11
    s_add_u32 s12, s12, 165888
    v_and_b32 v30, 15, v0
    v_lshl_add_u32 v30, v30, 7, s12
    v_mov_b32 v31, 1
    s_barrier
    s_cmp_eq_u32 s13, 4
    s_cbranch_scc0 mega_arrived
    s_mov_b64 exec, 0xffff
    global_atomic_add v30, v31, s[22:23] sc1
    s_mov_b64 exec, -1
mega_arrived:
    s_cmp_ge_u32 s2, 256
    s_cbranch_scc1 cd_exit
    s_load_dwordx2 s[20:21], s[0:1], 144
    s_load_dwordx4 s[44:47], s[0:1], 96
    s_load_dwordx2 s[48:49], s[0:1], 128
    s_and_b32 s6, s2, 7
    s_lshr_b32 s7, s2, 3
    s_and_b32 s4, s6, 3
    s_lshl_b32 s4, s4, 2
    s_and_b32 s12, s7, 3
    s_add_u32 s4, s4, s12
    s_lshr_b32 s5, s6, 2
    s_lshl_b32 s5, s5, 3
    s_lshr_b32 s13, s7, 2
    s_add_u32 s5, s5, s13
    s_lshl_b32 s52, s6, 2
    s_add_u32 s52, s52, s12
    s_mov_b32 s53, s13
    v_lshrrev_b32 v3, 6, v0
    v_and_b32 v1, 63, v0
    v_lshlrev_b32 v4, 4, v1
    v_readfirstlane_b32 s26, v3
    s_cmp_lt_u32 s26, 4
    s_cbranch_scc1 cd_compute
    s_sub_u32 s26, s26, 4
    v_lshrrev_b32 v5, 4, v1
    v_lshlrev_b32 v6, 2, v5
    v_and_b32 v7, 15, v1
    v_xor_b32 v6, v6, v7
    v_lshlrev_b32 v6, 4, v6
    v_lshl_add_u32 v5, v5, 12, v6
    s_mul_i32 s6, s5, 98304
    s_add_u32 s6, s6, 10485760
    s_mul_i32 s7, s26, 3
    s_add_u32 s12, s7, 0
    s_lshr_b32 s13, s12, 2
    s_and_b32 s12, s12, 3
    s_lshl_b32 s13, s13, 15
    s_lshl_b32 s12, s12, 10
    s_add_u32 s12, s12, s13
    s_add_u32 s30, s12, s6
    s_add_u32 s12, s7, 1
    s_lshr_b32 s13, s12, 2
    s_and_b32 s12, s12, 3
    s_lshl_b32 s13, s13, 15
    s_lshl_b32 s12, s12, 10
    s_add_u32 s12, s12, s13
    s_add_u32 s31, s12, s6
    s_add_u32 s12, s7, 2
    s_lshr_b32 s13, s12, 2
    s_and_b32 s12, s12, 3
    s_lshl_b32 s13, s13, 15
    s_lshl_b32 s12, s12, 10
    s_add_u32 s12, s12, s13
    s_add_u32 s32, s12, s6
    s_lshl_b32 s12, s26, 16
    s_lshl_b32 s13, s4, 8
    s_add_u32 s12, s12, s13
    s_add_u32 s33, s12, 12582912
    s_mul_i32 s34, s26, 3072
    s_lshl_b32 s35, s26, 12
    s_add_u32 s35, s35, 12288
    s_lshl_b32 s12, s4, 7
    s_add_u32 s12, s12, 163840
    v_mov_b32 v20, s12
    s_lshr_b32 s12, s52, 1
    s_lshl_b32 s12, s12, 7
    s_add_u32 s12, s12, 163840
    v_mov_b32 v21, s12
    s_waitcnt lgkmcnt(0)
    s_mov_b32 s8, s20
    s_mov_b32 s9, s21
    s_mov_b32 s10, 268435456
    s_mov_b32 s11, 0x00020000
    s_cmp_eq_u32 s26, 0
    s_cbranch_scc0 mg_wait
    s_lshr_b32 s12, s2, 3
    s_and_b32 s12, s12, 15
    s_lshl_b32 s12, s12, 7
    s_add_u32 s12, s12, 165888
    v_and_b32 v30, 7, v1
    v_lshl_add_u32 v30, v30, 11, s12
    v_mov_b32 v34, 0
    s_mov_b32 s60, 0
mg_poll:
    s_mov_b64 exec, 0xff
    global_atomic_add v32, v30, v34, s[20:21] sc0 sc1
    s_waitcnt vmcnt(0)
    v_cmp_ne_u32 vcc, 32, v32
    s_mov_b64 exec, -1
    s_cbranch_vccz mg_wait
    s_add_u32 s60, s60, 1
    s_sleep 1
    s_cmp_lt_u32 s60, 131072
    s_cbranch_scc1 mg_poll
mg_wait:
    s_barrier
    s_cmp_ge_u32 s5, 15
    s_cbranch_scc1 cd_ld_noC
    s_and_b32 s37, 0, 7
    s_lshl_b32 s38, s37, 18
    s_lshl_b32 s37, s37, 12
    s_add_u32 s38, s38, s33
    s_add_u32 m0, s35, 0
    s_nop 0
    buffer_load_dwordx4 v5, s[8:11], s38 offen lds
    s_add_u32 m0, s35, 1024
    s_add_u32 s38, s38, 16384
    buffer_load_dwordx4 v5, s[8:11], s38 offen lds
    s_add_u32 m0, s35, 2048
    s_add_u32 s38, s38, 16384
    buffer_load_dwordx4 v5, s[8:11], s38 offen lds
    s_add_u32 m0, s35, 3072
    s_add_u32 s38, s38, 16384
    buffer_load_dwordx4 v5, s[8:11], s38 offen lds
    s_add_u32 m0, s34, 0
    s_add_u32 s12, s30, s37
    buffer_load_dwordx4 v4, s[8:11], s12 offen lds
    s_add_u32 m0, s34, 1024
    s_add_u32 s12, s31, s37
    buffer_load_dwordx4 v4, s[8:11], s12 offen lds
    s_add_u32 m0, s34, 2048
    s_add_u32 s12, s32, s37
    buffer_load_dwordx4 v4, s[8:11], s12 offen lds
    s_and_b32 s37, 1, 7
    s_lshl_b32 s38, s37, 18
    s_lshl_b32 s37, s37, 12
    s_add_u32 s38, s38, s33
    s_add_u32 m0, s35, 28672
    s_nop 0
    buffer_load_dwordx4 v5, s[8:11], s38 offen lds
    s_add_u32 m0, s35, 29696
    s_add_u32 s38, s38, 16384
    buffer_load_dwordx4 v5, s[8:11], s38 offen lds
    s_add_u32 m0, s35, 30720
    s_add_u32 s38, s38, 16384
    buffer_load_dwordx4 v5, s[8:11], s38 offen lds
    s_add_u32 m0, s35, 31744
    s_add_u32 s38, s38, 16384
    buffer_load_dwordx4 v5, s[8:11], s38 offen lds
    s_add_u32 m0, s34, 28672
    s_add_u32 s12, s30, s37
    buffer_load_dwordx4 v4, s[8:11], s12 offen lds
    s_add_u32 m0, s34, 29696
    s_add_u32 s12, s31, s37
    buffer_load_dwordx4 v4, s[8:11], s12 offen lds
    s_add_u32 m0, s34, 30720
    s_add_u32 s12, s32, s37
    buffer_load_dwordx4 v4, s[8:11], s12 offen lds
    s_waitcnt vmcnt(7)
    s_barrier
    s_and_b32 s37, 2, 7
    s_lshl_b32 s38, s37, 18
    s_lshl_b32 s37, s37, 12
    s_add_u32 s38, s38, s33
    s_add_u32 m0, s35, 57344
    s_nop 0
    buffer_load_dwordx4 v5, s[8:11], s38 offen lds
    s_add_u32 m0, s35, 58368
    s_add_u32 s38, s38, 16384
    buffer_load_dwordx4 v5, s[8:11], s38 offen lds
    s_add_u32 m0, s35, 59392
    s_add_u32 s38, s38, 16384
    buffer_load_dwordx4 v5, s[8:11], s38 offen lds
    s_add_u32 m0, s35, 60416
    s_add_u32 s38, s38, 16384
    buffer_load_dwordx4 v5, s[8:11], s38 offen lds
    s_add_u32 m0, s34, 57344
    s_add_u32 s12, s30, s37
    buffer_load_dwordx4 v4, s[8:11], s12 offen lds
    s_add_u32 m0, s34, 58368
    s_add_u32 s12, s31, s37
    buffer_load_dwordx4 v4, s[8:11], s12 offen lds
    s_add_u32 m0, s34, 59392
    s_add_u32 s12, s32, s37
    buffer_load_dwordx4 v4, s[8:11], s12 offen lds
    s_waitcnt vmcnt(7)
    s_barrier
    s_and_b32 s37, 3, 7
    s_lshl_b32 s38, s37, 18
    s_lshl_b32 s37, s37, 12
    s_add_u32 s38, s38, s33
    s_add_u32 m0, s35, 86016
    s_nop 0
    buffer_load_dwordx4 v5, s[8:11], s38 offen lds
    s_add_u32 m0, s35, 87040
    s_add_u32 s38, s38, 16384
    buffer_load_dwordx4 v5, s[8:11], s38 offen lds
    s_add_u32 m0, s35, 88064
    s_add_u32 s38, s38, 16384
    buffer_load_dwordx4 v5, s[8:11], s38 offen lds
    s_add_u32 m0, s35, 89088
    s_add_u32 s38, s38, 16384
    buffer_load_dwordx4 v5, s[8:11], s38 offen lds
    s_add_u32 m0, s34, 86016
    s_add_u32 s12, s30, s37
    buffer_load_dwordx4 v4, s[8:11], s12 offen lds
    s_add_u32 m0, s34, 87040
    s_add_u32 s12, s31, s37
    buffer_load_dwordx4 v4, s[8:11], s12 offen lds
    s_add_u32 m0, s34, 88064
    s_add_u32 s12, s32, s37
    buffer_load_dwordx4 v4, s[8:11], s12 offen lds
    s_waitcnt vmcnt(7)
    s_barrier
    s_and_b32 s37, 4, 7
    s_lshl_b32 s38, s37, 18
    s_lshl_b32 s37, s37, 12
    s_add_u32 s38, s38, s33
    s_add_u32 m0, s35, 0
    s_nop 0
    buffer_load_dwordx4 v5, s[8:11], s38 offen lds
    s_add_u32 m0, s35, 1024
    s_add_u32 s38, s38, 16384
    buffer_load_dwordx4 v5, s[8:11], s38 offen lds
    s_add_u32 m0, s35, 2048
    s_add_u32 s38, s38, 16384
    buffer_load_dwordx4 v5, s[8:11], s38 offen lds
    s_add_u32 m0, s35, 3072
    s_add_u32 s38, s38, 16384
    buffer_load_dwordx4 v5, s[8:11], s38 offen lds
    s_add_u32 m0, s34, 0
    s_add_u32 s12, s30, s37
    buffer_load_dwordx4 v4, s[8:11], s12 offen lds
    s_add_u32 m0, s34, 1024
    s_add_u32 s12, s31, s37
    buffer_load_dwordx4 v4, s[8:11], s12 offen lds
    s_add_u32 m0, s34, 2048
    s_add_u32 s12, s32, s37
    buffer_load_dwordx4 v4, s[8:11], s12 offen lds
    s_waitcnt vmcnt(7)
    s_barrier
    s_and_b32 s37, 5, 7
    s_lshl_b32 s38, s37, 18
    s_lshl_b32 s37, s37, 12
    s_add_u32 s38, s38, s33
    s_add_u32 m0, s35, 28672
    s_nop 0
    buffer_load_dwordx4 v5, s[8:11], s38 offen lds
    s_add_u32 m0, s35, 29696
    s_add_u32 s38, s38, 16384
    buffer_load_dwordx4 v5, s[8:11], s38 offen lds
    s_add_u32 m0, s35, 30720
    s_add_u32 s38, s38, 16384
    buffer_load_dwordx4 v5, s[8:11], s38 offen lds
    s_add_u32 m0, s35, 31744
    s_add_u32 s38, s38, 16384
    buffer_load_dwordx4 v5, s[8:11], s38 offen lds
    s_add_u32 m0, s34, 28672
    s_add_u32 s12, s30, s37
    buffer_load_dwordx4 v4, s[8:11], s12 offen lds
    s_add_u32 m0, s34, 29696
    s_add_u32 s12, s31, s37
    buffer_load_dwordx4 v4, s[8:11], s12 offen lds
    s_add_u32 m0, s34, 30720
    s_add_u32 s12, s32, s37
    buffer_load_dwordx4 v4, s[8:11], s12 offen lds
    s_waitcnt vmcnt(7)
    s_barrier
    s_and_b32 s37, 6, 7
    s_lshl_b32 s38, s37, 18
    s_lshl_b32 s37, s37, 12
    s_add_u32 s38, s38, s33
    s_add_u32 m0, s35, 57344
    s_nop 0
    buffer_load_dwordx4 v5, s[8:11], s38 offen lds
    s_add_u32 m0, s35, 58368
    s_add_u32 s38, s38, 16384
    buffer_load_dwordx4 v5, s[8:11], s38 offen lds
    s_add_u32 m0, s35, 59392
    s_add_u32 s38, s38, 16384
    buffer_load_dwordx4 v5, s[8:11], s38 offen lds
    s_add_u32 m0, s35, 60416
    s_add_u32 s38, s38, 16384
    buffer_load_dwordx4 v5, s[8:11], s38 offen lds
    s_add_u32 m0, s34, 57344
    s_add_u32 s12, s30, s37
    buffer_load_dwordx4 v4, s[8:11], s12 offen lds
    s_add_u32 m0, s34, 58368
    s_add_u32 s12, s31, s37
    buffer_load_dwordx4 v4, s[8:11], s12 offen lds
    s_add_u32 m0, s34, 59392
    s_add_u32 s12, s32, s37
    buffer_load_dwordx4 v4, s[8:11], s12 offen lds
    s_waitcnt vmcnt(7)
    s_barrier
    s_and_b32 s37, 7, 7
    s_lshl_b32 s38, s37, 18
    s_lshl_b32 s37, s37, 12
    s_add_u32 s38, s38, s33
    s_add_u32 m0, s35, 86016
    s_nop 0
    buffer_load_dwordx4 v5, s[8:11], s38 offen lds
    s_add_u32 m0, s35, 87040
    s_add_u32 s38, s38, 16384
    buffer_load_dwordx4 v5, s[8:11], s38 offen lds
    s_add_u32 m0, s35, 88064
    s_add_u32 s38, s38, 16384
    buffer_load_dwordx4 v5, s[8:11], s38 offen lds
    s_add_u32 m0, s35, 89088
    s_add_u32 s38, s38, 16384
    buffer_load_dwordx4 v5, s[8:11], s38 offen lds
    s_add_u32 m0, s34, 86016
    s_add_u32 s12, s30, s37
    buffer_load_dwordx4 v4, s[8:11], s12 offen lds
    s_add_u32 m0, s34, 87040
    s_add_u32 s12, s31, s37
    buffer_load_dwordx4 v4, s[8:11], s12 offen lds
    s_add_u32 m0, s34, 88064
    s_add_u32 s12, s32, s37
    buffer_load_dwordx4 v4, s[8:11], s12 offen lds
    s_waitcnt vmcnt(7)
    s_barrier
    s_waitcnt vmcnt(0)
    s_barrier
    s_barrier
    s_branch cd_ld2
cd_ld_noC:
cd_ld2:
    s_and_b32 s27, s26, 1
    s_lshr_b32 s28, s26, 1
    s_and_b32 s6, s52, 3
    s_lshl_b32 s6, s6, 1
    s_add_u32 s36, s6, s53
    s_and_b32 s36, s36, 6
    s_mul_i32 s36, s36, 11
    s_lshr_b32 s36, s36, 3
    v_lshrrev_b32 v5, 3, v1
    v_bfe_u32 v6, v1, 4, 1
    v_lshlrev_b32 v6, 2, v6
    v_and_b32 v7, 7, v1
    v_xor_b32 v6, v6, v7
    v_lshlrev_b32 v6, 4, v6
    v_lshl_add_u32 v5, v5, 10, v6
    v_lshrrev_b32 v9, 3, v1
    v_lshl_add_u32 v9, v9, 12, v6
    s_lshl_b32 s31, s27, 13
    s_cmp_eq_u32 s28, 0
    s_cbranch_scc0 cd_hid
    s_mov_b32 s8, s44
    s_mov_b32 s9, s45
    s_mov_b32 s10, 1409024
    s_mov_b32 s11, 0x00020000
    s_lshl_b32 s30, s27, 16
    s_lshl_b32 s12, s53, 7
    s_add_u32 s30, s30, s12
    s_mov_b32 s32, 8192
    s_mov_b32 s33, 131072
    v_mov_b32 v8, v5
    s_mov_b32 s40, s20
    s_mov_b32 s41, s21
    s_mov_b32 s42, 268435456
    s_mov_b32 s43, 0x00020000
    s_add_u32 s34, s36, 0
    s_sub_u32 s35, s34, 11
    s_cmp_ge_u32 s34, 11
    s_cselect_b32 s34, s35, s34
    s_mul_i32 s34, s34, s33
    s_add_u32 s34, s34, s30
    s_add_u32 m0, s31, 0
    s_nop 0
    buffer_load_dwordx4 v8, s[8:11], s34 offen lds
    s_add_u32 m0, s31, 1024
    s_add_u32 s34, s34, s32
    buffer_load_dwordx4 v8, s[8:11], s34 offen lds
    s_add_u32 m0, s31, 2048
    s_add_u32 s34, s34, s32
    buffer_load_dwordx4 v8, s[8:11], s34 offen lds
    s_add_u32 m0, s31, 3072
    s_add_u32 s34, s34, s32
    buffer_load_dwordx4 v8, s[8:11], s34 offen lds
    s_add_u32 m0, s31, 4096
    s_add_u32 s34, s34, s32
    buffer_load_dwordx4 v8, s[8:11], s34 offen lds
    s_add_u32 m0, s31, 5120
    s_add_u32 s34, s34, s32
    buffer_load_dwordx4 v8, s[8:11], s34 offen lds
    s_add_u32 m0, s31, 6144
    s_add_u32 s34, s34, s32
    buffer_load_dwordx4 v8, s[8:11], s34 offen lds
    s_add_u32 m0, s31, 7168
    s_add_u32 s34, s34, s32
    buffer_load_dwordx4 v8, s[8:11], s34 offen lds
    s_lshl_b32 s12, s53, 6
    s_lshl_b32 s13, s27, 5
    s_add_u32 s12, s12, s13
    s_lshl_b32 s12, s12, 12
    s_lshl_b32 s13, s52, 7
    s_add_u32 s12, s12, s13
    s_add_u32 s12, s12, 12582912
    s_lshl_b32 s13, s27, 12
    s_add_u32 s13, s13, 147456
    s_add_u32 m0, s13, 0
    s_add_u32 s14, s12, 0
    buffer_load_dwordx4 v9, s[40:43], s14 offen lds
    s_add_u32 m0, s13, 1024
    s_add_u32 s14, s12, 32768
    buffer_load_dwordx4 v9, s[40:43], s14 offen lds
    s_add_u32 m0, s13, 2048
    s_add_u32 s14, s12, 65536
    buffer_load_dwordx4 v9, s[40:43], s14 offen lds
    s_add_u32 m0, s13, 3072
    s_add_u32 s14, s12, 98304
    buffer_load_dwordx4 v9, s[40:43], s14 offen lds
    s_add_u32 s34, s36, 1
    s_sub_u32 s35, s34, 11
    s_cmp_ge_u32 s34, 11
    s_cselect_b32 s34, s35, s34
    s_mul_i32 s34, s34, s33
    s_add_u32 s34, s34, s30
    s_add_u32 m0, s31, 16384
    s_nop 0
    buffer_load_dwordx4 v8, s[8:11], s34 offen lds
    s_add_u32 m0, s31, 17408
    s_add_u32 s34, s34, s32
    buffer_load_dwordx4 v8, s[8:11], s34 offen lds
    s_add_u32 m0, s31, 18432
    s_add_u32 s34, s34, s32
    buffer_load_dwordx4 v8, s[8:11], s34 offen lds
    s_add_u32 m0, s31, 19456
    s_add_u32 s34, s34, s32
    buffer_load_dwordx4 v8, s[8:11], s34 offen lds
    s_add_u32 m0, s31, 20480
    s_add_u32 s34, s34, s32
    buffer_load_dwordx4 v8, s[8:11], s34 offen lds
    s_add_u32 m0, s31, 21504
    s_add_u32 s34, s34, s32
    buffer_load_dwordx4 v8, s[8:11], s34 offen lds
    s_add_u32 m0, s31, 22528
    s_add_u32 s34, s34, s32
    buffer_load_dwordx4 v8, s[8:11], s34 offen lds
    s_add_u32 m0, s31, 23552
    s_add_u32 s34, s34, s32
    buffer_load_dwordx4 v8, s[8:11], s34 offen lds
    s_add_u32 s34, s36, 2
    s_sub_u32 s35, s34, 11
    s_cmp_ge_u32 s34, 11
    s_cselect_b32 s34, s35, s34
    s_mul_i32 s34, s34, s33
    s_add_u32 s34, s34, s30
    s_add_u32 m0, s31, 32768
    s_nop 0
    buffer_load_dwordx4 v8, s[8:11], s34 offen lds
    s_add_u32 m0, s31, 33792
    s_add_u32 s34, s34, s32
    buffer_load_dwordx4 v8, s[8:11], s34 offen lds
    s_add_u32 m0, s31, 34816
    s_add_u32 s34, s34, s32
    buffer_load_dwordx4 v8, s[8:11], s34 offen lds
    s_add_u32 m0, s31, 35840
    s_add_u32 s34, s34, s32
    buffer_load_dwordx4 v8, s[8:11], s34 offen lds
    s_add_u32 m0, s31, 36864
    s_add_u32 s34, s34, s32
    buffer_load_dwordx4 v8, s[8:11], s34 offen lds
    s_add_u32 m0, s31, 37888
    s_add_u32 s34, s34, s32
    buffer_load_dwordx4 v8, s[8:11], s34 offen lds
    s_add_u32 m0, s31, 38912
    s_add_u32 s34, s34, s32
    buffer_load_dwordx4 v8, s[8:11], s34 offen lds
    s_add_u32 m0, s31, 39936
    s_add_u32 s34, s34, s32
    buffer_load_dwordx4 v8, s[8:11], s34 offen lds
    s_add_u32 s34, s36, 3
    s_sub_u32 s35, s34, 11
    s_cmp_ge_u32 s34, 11
    s_cselect_b32 s34, s35, s34
    s_mul_i32 s34, s34, s33
    s_add_u32 s34, s34, s30
    s_add_u32 m0, s31, 49152
    s_nop 0
    buffer_load_dwordx4 v8, s[8:11], s34 offen lds
    s_add_u32 m0, s31, 50176
    s_add_u32 s34, s34, s32
    buffer_load_dwordx4 v8, s[8:11], s34 offen lds
    s_add_u32 m0, s31, 51200
    s_add_u32 s34, s34, s32
    buffer_load_dwordx4 v8, s[8:11], s34 offen lds
    s_add_u32 m0, s31, 52224
    s_add_u32 s34, s34, s32
    buffer_load_dwordx4 v8, s[8:11], s34 offen lds
    s_add_u32 m0, s31, 53248
    s_add_u32 s34, s34, s32
    buffer_load_dwordx4 v8, s[8:11], s34 offen lds
    s_add_u32 m0, s31, 54272
    s_add_u32 s34, s34, s32
    buffer_load_dwordx4 v8, s[8:11], s34 offen lds
    s_add_u32 m0, s31, 55296
    s_add_u32 s34, s34, s32
    buffer_load_dwordx4 v8, s[8:11], s34 offen lds
    s_add_u32 m0, s31, 56320
    s_add_u32 s34, s34, s32
    buffer_load_dwordx4 v8, s[8:11], s34 offen lds
    s_add_u32 s34, s36, 4
    s_sub_u32 s35, s34, 11
    s_cmp_ge_u32 s34, 11
    s_cselect_b32 s34, s35, s34
    s_mul_i32 s34, s34, s33
    s_add_u32 s34, s34, s30
    s_add_u32 m0, s31, 65536
    s_nop 0
    buffer_load_dwordx4 v8, s[8:11], s34 offen lds
    s_add_u32 m0, s31, 66560
    s_add_u32 s34, s34, s32
    buffer_load_dwordx4 v8, s[8:11], s34 offen lds
    s_add_u32 m0, s31, 67584
    s_add_u32 s34, s34, s32
    buffer_load_dwordx4 v8, s[8:11], s34 offen lds
    s_add_u32 m0, s31, 68608
    s_add_u32 s34, s34, s32
    buffer_load_dwordx4 v8, s[8:11], s34 offen lds
    s_add_u32 m0, s31, 69632
    s_add_u32 s34, s34, s32
    buffer_load_dwordx4 v8, s[8:11], s34 offen lds
    s_add_u32 m0, s31, 70656
    s_add_u32 s34, s34, s32
    buffer_load_dwordx4 v8, s[8:11], s34 offen lds
    s_add_u32 m0, s31, 71680
    s_add_u32 s34, s34, s32
    buffer_load_dwordx4 v8, s[8:11], s34 offen lds
    s_add_u32 m0, s31, 72704
    s_add_u32 s34, s34, s32
    buffer_load_dwordx4 v8, s[8:11], s34 offen lds
    s_add_u32 s34, s36, 5
    s_sub_u32 s35, s34, 11
    s_cmp_ge_u32 s34, 11
    s_cselect_b32 s34, s35, s34
    s_mul_i32 s34, s34, s33
    s_add_u32 s34, s34, s30
    s_add_u32 m0, s31, 81920
    s_nop 0
    buffer_load_dwordx4 v8, s[8:11], s34 offen lds
    s_add_u32 m0, s31, 82944
    s_add_u32 s34, s34, s32
    buffer_load_dwordx4 v8, s[8:11], s34 offen lds
    s_add_u32 m0, s31, 83968
    s_add_u32 s34, s34, s32
    buffer_load_dwordx4 v8, s[8:11], s34 offen lds
    s_add_u32 m0, s31, 84992
    s_add_u32 s34, s34, s32
    buffer_load_dwordx4 v8, s[8:11], s34 offen lds
    s_add_u32 m0, s31, 86016
    s_add_u32 s34, s34, s32
    buffer_load_dwordx4 v8, s[8:11], s34 offen lds
    s_add_u32 m0, s31, 87040
    s_add_u32 s34, s34, s32
    buffer_load_dwordx4 v8, s[8:11], s34 offen lds
    s_add_u32 m0, s31, 88064
    s_add_u32 s34, s34, s32
    buffer_load_dwordx4 v8, s[8:11], s34 offen lds
    s_add_u32 m0, s31, 89088
    s_add_u32 s34, s34, s32
    buffer_load_dwordx4 v8, s[8:11], s34 offen lds
    s_waitcnt vmcnt(40)
    s_barrier
    s_waitcnt vmcnt(40)
    s_barrier
    s_waitcnt vmcnt(32)
    s_barrier
    s_add_u32 s34, s36, 6
    s_sub_u32 s35, s34, 11
    s_cmp_ge_u32 s34, 11
    s_cselect_b32 s34, s35, s34
    s_mul_i32 s34, s34, s33
    s_add_u32 s34, s34, s30
    s_add_u32 m0, s31, 0
    s_nop 0
    buffer_load_dwordx4 v8, s[8:11], s34 offen lds
    s_add_u32 m0, s31, 1024
    s_add_u32 s34, s34, s32
    buffer_load_dwordx4 v8, s[8:11], s34 offen lds
    s_add_u32 m0, s31, 2048
    s_add_u32 s34, s34, s32
    buffer_load_dwordx4 v8, s[8:11], s34 offen lds
    s_add_u32 m0, s31, 3072
    s_add_u32 s34, s34, s32
    buffer_load_dwordx4 v8, s[8:11], s34 offen lds
    s_add_u32 m0, s31, 4096
    s_add_u32 s34, s34, s32
    buffer_load_dwordx4 v8, s[8:11], s34 offen lds
    s_add_u32 m0, s31, 5120
    s_add_u32 s34, s34, s32
    buffer_load_dwordx4 v8, s[8:11], s34 offen lds
    s_add_u32 m0, s31, 6144
    s_add_u32 s34, s34, s32
    buffer_load_dwordx4 v8, s[8:11], s34 offen lds
    s_add_u32 m0, s31, 7168
    s_add_u32 s34, s34, s32
    buffer_load_dwordx4 v8, s[8:11], s34 offen lds
    s_waitcnt vmcnt(32)
    s_barrier
    s_add_u32 s34, s36, 7
    s_sub_u32 s35, s34, 11
    s_cmp_ge_u32 s34, 11
    s_cselect_b32 s34, s35, s34
    s_mul_i32 s34, s34, s33
    s_add_u32 s34, s34, s30
    s_add_u32 m0, s31, 16384
    s_nop 0
    buffer_load_dwordx4 v8, s[8:11], s34 offen lds
    s_add_u32 m0, s31, 17408
    s_add_u32 s34, s34, s32
    buffer_load_dwordx4 v8, s[8:11], s34 offen lds
    s_add_u32 m0, s31, 18432
    s_add_u32 s34, s34, s32
    buffer_load_dwordx4 v8, s[8:11], s34 offen lds
    s_add_u32 m0, s31, 19456
    s_add_u32 s34, s34, s32
    buffer_load_dwordx4 v8, s[8:11], s34 offen lds
    s_add_u32 m0, s31, 20480
    s_add_u32 s34, s34, s32
    buffer_load_dwordx4 v8, s[8:11], s34 offen lds
    s_add_u32 m0, s31, 21504
    s_add_u32 s34, s34, s32
    buffer_load_dwordx4 v8, s[8:11], s34 offen lds
    s_add_u32 m0, s31, 22528
    s_add_u32 s34, s34, s32
    buffer_load_dwordx4 v8, s[8:11], s34 offen lds
    s_add_u32 m0, s31, 23552
    s_add_u32 s34, s34, s32
    buffer_load_dwordx4 v8, s[8:11], s34 offen lds
    s_waitcnt vmcnt(32)
    s_barrier
    s_add_u32 s34, s36, 8
    s_sub_u32 s35, s34, 11
    s_cmp_ge_u32 s34, 11
    s_cselect_b32 s34, s35, s34
    s_mul_i32 s34, s34, s33
    s_add_u32 s34, s34, s30
    s_add_u32 m0, s31, 32768
    s_nop 0
    buffer_load_dwordx4 v8, s[8:11], s34 offen lds
    s_add_u32 m0, s31, 33792
    s_add_u32 s34, s34, s32
    buffer_load_dwordx4 v8, s[8:11], s34 offen lds
    s_add_u32 m0, s31, 34816
    s_add_u32 s34, s34, s32
    buffer_load_dwordx4 v8, s[8:11], s34 offen lds
    s_add_u32 m0, s31, 35840
    s_add_u32 s34, s34, s32
    buffer_load_dwordx4 v8, s[8:11], s34 offen lds
    s_add_u32 m0, s31, 36864
    s_add_u32 s34, s34, s32
    buffer_load_dwordx4 v8, s[8:11], s34 offen lds
    s_add_u32 m0, s31, 37888
    s_add_u32 s34, s34, s32
    buffer_load_dwordx4 v8, s[8:11], s34 offen lds
    s_add_u32 m0, s31, 38912
    s_add_u32 s34, s34, s32
    buffer_load_dwordx4 v8, s[8:11], s34 offen lds
    s_add_u32 m0, s31, 39936
    s_add_u32 s34, s34, s32
    buffer_load_dwordx4 v8, s[8:11], s34 offen lds
    s_waitcnt vmcnt(32)
    s_barrier
    s_add_u32 s34, s36, 9
    s_sub_u32 s35, s34, 11
    s_cmp_ge_u32 s34, 11
    s_cselect_b32 s34, s35, s34
    s_mul_i32 s34, s34, s33
    s_add_u32 s34, s34, s30
    s_add_u32 m0, s31, 49152
    s_nop 0
    buffer_load_dwordx4 v8, s[8:11], s34 offen lds
    s_add_u32 m0, s31, 50176
    s_add_u32 s34, s34, s32
    buffer_load_dwordx4 v8, s[8:11], s34 offen lds
    s_add_u32 m0, s31, 51200
    s_add_u32 s34, s34, s32
    buffer_load_dwordx4 v8, s[8:11], s34 offen lds
    s_add_u32 m0, s31, 52224
    s_add_u32 s34, s34, s32
    buffer_load_dwordx4 v8, s[8:11], s34 offen lds
    s_add_u32 m0, s31, 53248
    s_add_u32 s34, s34, s32
    buffer_load_dwordx4 v8, s[8:11], s34 offen lds
    s_add_u32 m0, s31, 54272
    s_add_u32 s34, s34, s32
    buffer_load_dwordx4 v8, s[8:11], s34 offen lds
    s_add_u32 m0, s31, 55296
    s_add_u32 s34, s34, s32
    buffer_load_dwordx4 v8, s[8:11], s34 offen lds
    s_add_u32 m0, s31, 56320
    s_add_u32 s34, s34, s32
    buffer_load_dwordx4 v8, s[8:11], s34 offen lds
    s_waitcnt vmcnt(32)
    s_barrier
    s_add_u32 s34, s36, 10
    s_sub_u32 s35, s34, 11
    s_cmp_ge_u32 s34, 11
    s_cselect_b32 s34, s35, s34
    s_mul_i32 s34, s34, s33
    s_add_u32 s34, s34, s30
    s_add_u32 m0, s31, 65536
    s_nop 0
    buffer_load_dwordx4 v8, s[8:11], s34 offen lds
    s_add_u32 m0, s31, 66560
    s_add_u32 s34, s34, s32
    buffer_load_dwordx4 v8, s[8:11], s34 offen lds
    s_add_u32 m0, s31, 67584
    s_add_u32 s34, s34, s32
    buffer_load_dwordx4 v8, s[8:11], s34 offen lds
    s_add_u32 m0, s31, 68608
    s_add_u32 s34, s34, s32
    buffer_load_dwordx4 v8, s[8:11], s34 offen lds
    s_add_u32 m0, s31, 69632
    s_add_u32 s34, s34, s32
    buffer_load_dwordx4 v8, s[8:11], s34 offen lds
    s_add_u32 m0, s31, 70656
    s_add_u32 s34, s34, s32
    buffer_load_dwordx4 v8, s[8:11], s34 offen lds
    s_add_u32 m0, s31, 71680
    s_add_u32 s34, s34, s32
    buffer_load_dwordx4 v8, s[8:11], s34 offen lds
    s_add_u32 m0, s31, 72704
    s_add_u32 s34, s34, s32
    buffer_load_dwordx4 v8, s[8:11], s34 offen lds
    s_waitcnt vmcnt(32)
    s_barrier
    s_waitcnt vmcnt(24)
    s_barrier
    s_waitcnt vmcnt(16)
    s_barrier
    s_waitcnt vmcnt(8)
    s_barrier
    s_waitcnt vmcnt(0)
    s_barrier
    s_endpgm
cd_hid:
    s_mov_b32 s8, s20
    s_mov_b32 s9, s21
    s_mov_b32 s10, 268435456
    s_mov_b32 s11, 0x00020000
    s_lshl_b32 s30, s52, 1
    s_add_u32 s30, s30, s27
    s_mul_i32 s30, s30, 90112
    s_add_u32 s30, s30, 16777216
    s_mov_b32 s32, 1024
    s_mov_b32 s33, 8192
    v_mov_b32 v8, v4
    v_mov_b32 v24, 156160
    s_barrier
    s_cmp_eq_u32 s27, 0
    s_cbranch_scc0 cd_relay
    s_cmp_ge_u32 s5, 15
    s_cbranch_scc1 cd_noarr
    v_mov_b32 v26, 1
    s_mov_b64 exec, 1
    global_atomic_add v20, v26, s[20:21] sc1
    s_mov_b64 exec, -1
cd_noarr:
    s_mov_b32 s60, 0
    v_mov_b32 v26, 0
cd_poll:
    s_mov_b64 exec, 1
    global_atomic_add v27, v21, v26, s[20:21] sc0 sc1
    s_mov_b64 exec, -1
    s_waitcnt vmcnt(0)
    v_readfirstlane_b32 s12, v27
    s_nop 0
    s_cmp_eq_u32 s12, 15
    s_cbranch_scc1 cd_go
    s_add_u32 s60, s60, 1
    s_sleep 1
    s_cmp_lt_u32 s60, 131072
    s_cbranch_scc1 cd_poll
cd_go:
    v_mov_b32 v25, 1
    ds_write_b32 v24, v25
    s_branch cd_released
cd_relay:
    ds_read_b32 v25, v24
    s_waitcnt lgkmcnt(0)
    v_readfirstlane_b32 s12, v25
    s_cmp_eq_u32 s12, 1
    s_cbranch_scc1 cd_released
    s_sleep 1
    s_branch cd_relay
cd_released:
    s_add_u32 s34, s36, 0
    s_sub_u32 s35, s34, 11
    s_cmp_ge_u32 s34, 11
    s_cselect_b32 s34, s35, s34
    s_mul_i32 s34, s34, s33
    s_add_u32 s34, s34, s30
    s_add_u32 m0, s31, 98304
    s_nop 0
    buffer_load_dwordx4 v8, s[8:11], s34 offen sc1 lds
    s_add_u32 m0, s31, 99328
    s_add_u32 s34, s34, s32
    buffer_load_dwordx4 v8, s[8:11], s34 offen sc1 lds
    s_add_u32 m0, s31, 100352
    s_add_u32 s34, s34, s32
    buffer_load_dwordx4 v8, s[8:11], s34 offen sc1 lds
    s_add_u32 m0, s31, 101376
    s_add_u32 s34, s34, s32
    buffer_load_dwordx4 v8, s[8:11], s34 offen sc1 lds
    s_add_u32 m0, s31, 102400
    s_add_u32 s34, s34, s32
    buffer_load_dwordx4 v8, s[8:11], s34 offen sc1 lds
    s_add_u32 m0, s31, 103424
    s_add_u32 s34, s34, s32
    buffer_load_dwordx4 v8, s[8:11], s34 offen sc1 lds
    s_add_u32 m0, s31, 104448
    s_add_u32 s34, s34, s32
    buffer_load_dwordx4 v8, s[8:11], s34 offen sc1 lds
    s_add_u32 m0, s31, 105472
    s_add_u32 s34, s34, s32
    buffer_load_dwordx4 v8, s[8:11], s34 offen sc1 lds
    s_add_u32 s34, s36, 1
    s_sub_u32 s35, s34, 11
    s_cmp_ge_u32 s34, 11
    s_cselect_b32 s34, s35, s34
    s_mul_i32 s34, s34, s33
    s_add_u32 s34, s34, s30
    s_add_u32 m0, s31, 114688
    s_nop 0
    buffer_load_dwordx4 v8, s[8:11], s34 offen sc1 lds
    s_add_u32 m0, s31, 115712
    s_add_u32 s34, s34, s32
    buffer_load_dwordx4 v8, s[8:11], s34 offen sc1 lds
    s_add_u32 m0, s31, 116736
    s_add_u32 s34, s34, s32
    buffer_load_dwordx4 v8, s[8:11], s34 offen sc1 lds
    s_add_u32 m0, s31, 117760
    s_add_u32 s34, s34, s32
    buffer_load_dwordx4 v8, s[8:11], s34 offen sc1 lds
    s_add_u32 m0, s31, 118784
    s_add_u32 s34, s34, s32
    buffer_load_dwordx4 v8, s[8:11], s34 offen sc1 lds
    s_add_u32 m0, s31, 119808
    s_add_u32 s34, s34, s32
    buffer_load_dwordx4 v8, s[8:11], s34 offen sc1 lds
    s_add_u32 m0, s31, 120832
    s_add_u32 s34, s34, s32
    buffer_load_dwordx4 v8, s[8:11], s34 offen sc1 lds
    s_add_u32 m0, s31, 121856
    s_add_u32 s34, s34, s32
    buffer_load_dwordx4 v8, s[8:11], s34 offen sc1 lds
    s_waitcnt vmcnt(8)
    s_barrier
    s_add_u32 s34, s36, 2
    s_sub_u32 s35, s34, 11
    s_cmp_ge_u32 s34, 11
    s_cselect_b32 s34, s35, s34
    s_mul_i32 s34, s34, s33
    s_add_u32 s34, s34, s30
    s_add_u32 m0, s31, 131072
    s_nop 0
    buffer_load_dwordx4 v8, s[8:11], s34 offen sc1 lds
    s_add_u32 m0, s31, 132096
    s_add_u32 s34, s34, s32
    buffer_load_dwordx4 v8, s[8:11], s34 offen sc1 lds
    s_add_u32 m0, s31, 133120
    s_add_u32 s34, s34, s32
    buffer_load_dwordx4 v8, s[8:11], s34 offen sc1 lds
    s_add_u32 m0, s31, 134144
    s_add_u32 s34, s34, s32
    buffer_load_dwordx4 v8, s[8:11], s34 offen sc1 lds
    s_add_u32 m0, s31, 135168
    s_add_u32 s34, s34, s32
    buffer_load_dwordx4 v8, s[8:11], s34 offen sc1 lds
    s_add_u32 m0, s31, 136192
    s_add_u32 s34, s34, s32
    buffer_load_dwordx4 v8, s[8:11], s34 offen sc1 lds
    s_add_u32 m0, s31, 137216
    s_add_u32 s34, s34, s32
    buffer_load_dwordx4 v8, s[8:11], s34 offen sc1 lds
    s_add_u32 m0, s31, 138240
    s_add_u32 s34, s34, s32
    buffer_load_dwordx4 v8, s[8:11], s34 offen sc1 lds
    s_waitcnt vmcnt(8)
    s_barrier
    s_add_u32 s34, s36, 3
    s_sub_u32 s35, s34, 11
    s_cmp_ge_u32 s34, 11
    s_cselect_b32 s34, s35, s34
    s_mul_i32 s34, s34, s33
    s_add_u32 s34, s34, s30
    s_add_u32 m0, s31, 98304
    s_nop 0
    buffer_load_dwordx4 v8, s[8:11], s34 offen sc1 lds
    s_add_u32 m0, s31, 99328
    s_add_u32 s34, s34, s32
    buffer_load_dwordx4 v8, s[8:11], s34 offen sc1 lds
    s_add_u32 m0, s31, 100352
    s_add_u32 s34, s34, s32
    buffer_load_dwordx4 v8, s[8:11], s34 offen sc1 lds
    s_add_u32 m0, s31, 101376
    s_add_u32 s34, s34, s32
    buffer_load_dwordx4 v8, s[8:11], s34 offen sc1 lds
    s_add_u32 m0, s31, 102400
    s_add_u32 s34, s34, s32
    buffer_load_dwordx4 v8, s[8:11], s34 offen sc1 lds
    s_add_u32 m0, s31, 103424
    s_add_u32 s34, s34, s32
    buffer_load_dwordx4 v8, s[8:11], s34 offen sc1 lds
    s_add_u32 m0, s31, 104448
    s_add_u32 s34, s34, s32
    buffer_load_dwordx4 v8, s[8:11], s34 offen sc1 lds
    s_add_u32 m0, s31, 105472
    s_add_u32 s34, s34, s32
    buffer_load_dwordx4 v8, s[8:11], s34 offen sc1 lds
    s_waitcnt vmcnt(8)
    s_barrier
    s_add_u32 s34, s36, 4
    s_sub_u32 s35, s34, 11
    s_cmp_ge_u32 s34, 11
    s_cselect_b32 s34, s35, s34
    s_mul_i32 s34, s34, s33
    s_add_u32 s34, s34, s30
    s_add_u32 m0, s31, 114688
    s_nop 0
    buffer_load_dwordx4 v8, s[8:11], s34 offen sc1 lds
    s_add_u32 m0, s31, 115712
    s_add_u32 s34, s34, s32
    buffer_load_dwordx4 v8, s[8:11], s34 offen sc1 lds
    s_add_u32 m0, s31, 116736
    s_add_u32 s34, s34, s32
    buffer_load_dwordx4 v8, s[8:11], s34 offen sc1 lds
    s_add_u32 m0, s31, 117760
    s_add_u32 s34, s34, s32
    buffer_load_dwordx4 v8, s[8:11], s34 offen sc1 lds
    s_add_u32 m0, s31, 118784
    s_add_u32 s34, s34, s32
    buffer_load_dwordx4 v8, s[8:11], s34 offen sc1 lds
    s_add_u32 m0, s31, 119808
    s_add_u32 s34, s34, s32
    buffer_load_dwordx4 v8, s[8:11], s34 offen sc1 lds
    s_add_u32 m0, s31, 120832
    s_add_u32 s34, s34, s32
    buffer_load_dwordx4 v8, s[8:11], s34 offen sc1 lds
    s_add_u32 m0, s31, 121856
    s_add_u32 s34, s34, s32
    buffer_load_dwordx4 v8, s[8:11], s34 offen sc1 lds
    s_waitcnt vmcnt(8)
    s_barrier
    s_add_u32 s34, s36, 5
    s_sub_u32 s35, s34, 11
    s_cmp_ge_u32 s34, 11
    s_cselect_b32 s34, s35, s34
    s_mul_i32 s34, s34, s33
    s_add_u32 s34, s34, s30
    s_add_u32 m0, s31, 131072
    s_nop 0
    buffer_load_dwordx4 v8, s[8:11], s34 offen sc1 lds
    s_add_u32 m0, s31, 132096
    s_add_u32 s34, s34, s32
    buffer_load_dwordx4 v8, s[8:11], s34 offen sc1 lds
    s_add_u32 m0, s31, 133120
    s_add_u32 s34, s34, s32
    buffer_load_dwordx4 v8, s[8:11], s34 offen sc1 lds
    s_add_u32 m0, s31, 134144
    s_add_u32 s34, s34, s32
    buffer_load_dwordx4 v8, s[8:11], s34 offen sc1 lds
    s_add_u32 m0, s31, 135168
    s_add_u32 s34, s34, s32
    buffer_load_dwordx4 v8, s[8:11], s34 offen sc1 lds
    s_add_u32 m0, s31, 136192
    s_add_u32 s34, s34, s32
    buffer_load_dwordx4 v8, s[8:11], s34 offen sc1 lds
    s_add_u32 m0, s31, 137216
    s_add_u32 s34, s34, s32
    buffer_load_dwordx4 v8, s[8:11], s34 offen sc1 lds
    s_add_u32 m0, s31, 138240
    s_add_u32 s34, s34, s32
    buffer_load_dwordx4 v8, s[8:11], s34 offen sc1 lds
    s_waitcnt vmcnt(8)
    s_barrier
    s_add_u32 s34, s36, 6
    s_sub_u32 s35, s34, 11
    s_cmp_ge_u32 s34, 11
    s_cselect_b32 s34, s35, s34
    s_mul_i32 s34, s34, s33
    s_add_u32 s34, s34, s30
    s_add_u32 m0, s31, 98304
    s_nop 0
    buffer_load_dwordx4 v8, s[8:11], s34 offen sc1 lds
    s_add_u32 m0, s31, 99328
    s_add_u32 s34, s34, s32
    buffer_load_dwordx4 v8, s[8:11], s34 offen sc1 lds
    s_add_u32 m0, s31, 100352
    s_add_u32 s34, s34, s32
    buffer_load_dwordx4 v8, s[8:11], s34 offen sc1 lds
    s_add_u32 m0, s31, 101376
    s_add_u32 s34, s34, s32
    buffer_load_dwordx4 v8, s[8:11], s34 offen sc1 lds
    s_add_u32 m0, s31, 102400
    s_add_u32 s34, s34, s32
    buffer_load_dwordx4 v8, s[8:11], s34 offen sc1 lds
    s_add_u32 m0, s31, 103424
    s_add_u32 s34, s34, s32
    buffer_load_dwordx4 v8, s[8:11], s34 offen sc1 lds
    s_add_u32 m0, s31, 104448
    s_add_u32 s34, s34, s32
    buffer_load_dwordx4 v8, s[8:11], s34 offen sc1 lds
    s_add_u32 m0, s31, 105472
    s_add_u32 s34, s34, s32
    buffer_load_dwordx4 v8, s[8:11], s34 offen sc1 lds
    s_waitcnt vmcnt(8)
    s_barrier
    s_add_u32 s34, s36, 7
    s_sub_u32 s35, s34, 11
    s_cmp_ge_u32 s34, 11
    s_cselect_b32 s34, s35, s34
    s_mul_i32 s34, s34, s33
    s_add_u32 s34, s34, s30
    s_add_u32 m0, s31, 114688
    s_nop 0
    buffer_load_dwordx4 v8, s[8:11], s34 offen sc1 lds
    s_add_u32 m0, s31, 115712
    s_add_u32 s34, s34, s32
    buffer_load_dwordx4 v8, s[8:11], s34 offen sc1 lds
    s_add_u32 m0, s31, 116736
    s_add_u32 s34, s34, s32
    buffer_load_dwordx4 v8, s[8:11], s34 offen sc1 lds
    s_add_u32 m0, s31, 117760
    s_add_u32 s34, s34, s32
    buffer_load_dwordx4 v8, s[8:11], s34 offen sc1 lds
    s_add_u32 m0, s31, 118784
    s_add_u32 s34, s34, s32
    buffer_load_dwordx4 v8, s[8:11], s34 offen sc1 lds
    s_add_u32 m0, s31, 119808
    s_add_u32 s34, s34, s32
    buffer_load_dwordx4 v8, s[8:11], s34 offen sc1 lds
    s_add_u32 m0, s31, 120832
    s_add_u32 s34, s34, s32
    buffer_load_dwordx4 v8, s[8:11], s34 offen sc1 lds
    s_add_u32 m0, s31, 121856
    s_add_u32 s34, s34, s32
    buffer_load_dwordx4 v8, s[8:11], s34 offen sc1 lds
    s_waitcnt vmcnt(8)
    s_barrier
    s_add_u32 s34, s36, 8
    s_sub_u32 s35, s34, 11
    s_cmp_ge_u32 s34, 11
    s_cselect_b32 s34, s35, s34
    s_mul_i32 s34, s34, s33
    s_add_u32 s34, s34, s30
    s_add_u32 m0, s31, 131072
    s_nop 0
    buffer_load_dwordx4 v8, s[8:11], s34 offen sc1 lds
    s_add_u32 m0, s31, 132096
    s_add_u32 s34, s34, s32
    buffer_load_dwordx4 v8, s[8:11], s34 offen sc1 lds
    s_add_u32 m0, s31, 133120
    s_add_u32 s34, s34, s32
    buffer_load_dwordx4 v8, s[8:11], s34 offen sc1 lds
    s_add_u32 m0, s31, 134144
    s_add_u32 s34, s34, s32
    buffer_load_dwordx4 v8, s[8:11], s34 offen sc1 lds
    s_add_u32 m0, s31, 135168
    s_add_u32 s34, s34, s32
    buffer_load_dwordx4 v8, s[8:11], s34 offen sc1 lds
    s_add_u32 m0, s31, 136192
    s_add_u32 s34, s34, s32
    buffer_load_dwordx4 v8, s[8:11], s34 offen sc1 lds
    s_add_u32 m0, s31, 137216
    s_add_u32 s34, s34, s32
    buffer_load_dwordx4 v8, s[8:11], s34 offen sc1 lds
    s_add_u32 m0, s31, 138240
    s_add_u32 s34, s34, s32
    buffer_load_dwordx4 v8, s[8:11], s34 offen sc1 lds
    s_waitcnt vmcnt(8)
    s_barrier
    s_add_u32 s34, s36, 9
    s_sub_u32 s35, s34, 11
    s_cmp_ge_u32 s34, 11
    s_cselect_b32 s34, s35, s34
    s_mul_i32 s34, s34, s33
    s_add_u32 s34, s34, s30
    s_add_u32 m0, s31, 98304
    s_nop 0
    buffer_load_dwordx4 v8, s[8:11], s34 offen sc1 lds
    s_add_u32 m0, s31, 99328
    s_add_u32 s34, s34, s32
    buffer_load_dwordx4 v8, s[8:11], s34 offen sc1 lds
    s_add_u32 m0, s31, 100352
    s_add_u32 s34, s34, s32
    buffer_load_dwordx4 v8, s[8:11], s34 offen sc1 lds
    s_add_u32 m0, s31, 101376
    s_add_u32 s34, s34, s32
    buffer_load_dwordx4 v8, s[8:11], s34 offen sc1 lds
    s_add_u32 m0, s31, 102400
    s_add_u32 s34, s34, s32
    buffer_load_dwordx4 v8, s[8:11], s34 offen sc1 lds
    s_add_u32 m0, s31, 103424
    s_add_u32 s34, s34, s32
    buffer_load_dwordx4 v8, s[8:11], s34 offen sc1 lds
    s_add_u32 m0, s31, 104448
    s_add_u32 s34, s34, s32
    buffer_load_dwordx4 v8, s[8:11], s34 offen sc1 lds
    s_add_u32 m0, s31, 105472
    s_add_u32 s34, s34, s32
    buffer_load_dwordx4 v8, s[8:11], s34 offen sc1 lds
    s_waitcnt vmcnt(8)
    s_barrier
    s_add_u32 s34, s36, 10
    s_sub_u32 s35, s34, 11
    s_cmp_ge_u32 s34, 11
    s_cselect_b32 s34, s35, s34
    s_mul_i32 s34, s34, s33
    s_add_u32 s34, s34, s30
    s_add_u32 m0, s31, 114688
    s_nop 0
    buffer_load_dwordx4 v8, s[8:11], s34 offen sc1 lds
    s_add_u32 m0, s31, 115712
    s_add_u32 s34, s34, s32
    buffer_load_dwordx4 v8, s[8:11], s34 offen sc1 lds
    s_add_u32 m0, s31, 116736
    s_add_u32 s34, s34, s32
    buffer_load_dwordx4 v8, s[8:11], s34 offen sc1 lds
    s_add_u32 m0, s31, 117760
    s_add_u32 s34, s34, s32
    buffer_load_dwordx4 v8, s[8:11], s34 offen sc1 lds
    s_add_u32 m0, s31, 118784
    s_add_u32 s34, s34, s32
    buffer_load_dwordx4 v8, s[8:11], s34 offen sc1 lds
    s_add_u32 m0, s31, 119808
    s_add_u32 s34, s34, s32
    buffer_load_dwordx4 v8, s[8:11], s34 offen sc1 lds
    s_add_u32 m0, s31, 120832
    s_add_u32 s34, s34, s32
    buffer_load_dwordx4 v8, s[8:11], s34 offen sc1 lds
    s_add_u32 m0, s31, 121856
    s_add_u32 s34, s34, s32
    buffer_load_dwordx4 v8, s[8:11], s34 offen sc1 lds
    s_waitcnt vmcnt(8)
    s_barrier
    s_waitcnt vmcnt(0)
    s_barrier
    s_endpgm
cd_compute:
    v_lshlrev_b32 v8, 2, v0
    s_mul_i32 s12, s5, 384
    s_add_u32 s13, s12, 32768
    s_add_u32 s12, s12, 40960
    v_and_b32 v6, 15, v1
    v_lshrrev_b32 v7, 2, v6
    v_and_b32 v6, 3, v6
    v_lshrrev_b32 v9, 5, v1
    v_lshl_add_u32 v12, v9, 3, v7
    v_lshlrev_b32 v12, 8, v12
    v_bfe_u32 v13, v1, 4, 1
    v_lshlrev_b32 v13, 1, v13
    v_lshl_add_u32 v13, v3, 2, v13
    v_lshrrev_b32 v14, 1, v6
    v_add_u32 v13, v13, v14
    v_lshlrev_b32 v14, 2, v7
    v_xor_b32 v13, v13, v14
    v_lshl_add_u32 v12, v13, 4, v12
    v_and_b32 v6, 1, v6
    v_lshl_add_u32 v12, v6, 3, v12
    v_add_u32 v16, 12288, v12
    v_add_u32 v17, 57344, v16
    v_mov_b32 v19, v4
    v_add_u32 v20, 57344, v4
    v_mov_b32 v22, 0x3f803f80
    v_mov_b32 v23, 0x3f803f80
    v_add_u32 v9, 114688, v8
    v_lshrrev_b32 v14, 4, v0
    v_lshlrev_b32 v14, 7, v14
    v_and_b32 v21, 15, v0
    v_lshl_add_u32 v14, v21, 2, v14
    s_lshl_b32 s16, s53, 9
    s_add_u32 s16, s16, 86016
    v_lshlrev_b32 v15, 1, v0
    s_lshl_b32 s17, s53, 7
    v_add_u32 v15, s17, v15
    v_min_u32 v15, 1022, v15
    v_add_u32 v18, 155648, v8
    v_mov_b32 v24, 0
    v_mov_b32 v25, 156160
    ds_write_b32 v25, v24
    s_waitcnt lgkmcnt(0)
    s_mov_b32 s8, s20
    s_mov_b32 s9, s21
    s_mov_b32 s10, 268435456
    s_mov_b32 s11, 0x00020000
    s_barrier
    buffer_load_dword v10, v8, s[8:11], s13 offen
    buffer_load_dword v11, v8, s[8:11], s12 offen
    buffer_load_dword v14, v14, s[8:11], s16 offen
    global_load_ushort v15, v15, s[46:47]
    s_cmp_ge_u32 s5, 15
    s_cbranch_scc0 cd_doC
    s_waitcnt vmcnt(0)
    v_lshlrev_b32 v15, 16, v15
    v_cmp_gt_u32 vcc, 96, v0
    s_and_saveexec_b64 s[14:15], vcc
    ds_write_b32 v9, v10
    ds_write_b32 v9, v11 offset:384
    s_mov_b64 exec, s[14:15]
    v_cmp_gt_u32 vcc, 64, v0
    s_and_saveexec_b64 s[14:15], vcc
    ds_write_b32 v18, v14
    ds_write_b32 v18, v15 offset:256
    s_mov_b64 exec, s[14:15]
    s_waitcnt lgkmcnt(0)
    s_branch cd_cmp2
cd_doC:
    v_mov_b32 v64, 0
    v_mov_b32 v65, 0
    v_mov_b32 v66, 0
    v_mov_b32 v67, 0
    v_mov_b32 v68, 0
    v_mov_b32 v69, 0
    v_mov_b32 v70, 0
    v_mov_b32 v71, 0
    v_mov_b32 v72, 0
    v_mov_b32 v73, 0
    v_mov_b32 v74, 0
    v_mov_b32 v75, 0
    v_mov_b32 v76, 0
    v_mov_b32 v77, 0
    v_mov_b32 v78, 0
    v_mov_b32 v79, 0
    v_mov_b32 v80, 0
    v_mov_b32 v81, 0
    v_mov_b32 v82, 0
    v_mov_b32 v83, 0
    v_mov_b32 v84, 0
    v_mov_b32 v85, 0
    v_mov_b32 v86, 0
    v_mov_b32 v87, 0
    v_mov_b32 v88, 0
    v_mov_b32 v89, 0
    v_mov_b32 v90, 0
    v_mov_b32 v91, 0
    v_mov_b32 v92, 0
    v_mov_b32 v93, 0
    v_mov_b32 v94, 0
    v_mov_b32 v95, 0
    v_mov_b32 v96, 0
    v_mov_b32 v97, 0
    v_mov_b32 v98, 0
    v_mov_b32 v99, 0
    v_mov_b32 v100, 0
    v_mov_b32 v101, 0
    v_mov_b32 v102, 0
    v_mov_b32 v103, 0
    v_mov_b32 v104, 0
    v_mov_b32 v105, 0
    v_mov_b32 v106, 0
    v_mov_b32 v107, 0
    v_mov_b32 v108, 0
    v_mov_b32 v109, 0
    v_mov_b32 v110, 0
    v_mov_b32 v111, 0
    v_mov_b32 v112, 0
    v_mov_b32 v113, 0
    v_mov_b32 v114, 0
    v_mov_b32 v115, 0
    v_mov_b32 v116, 0
    v_mov_b32 v117, 0
    v_mov_b32 v118, 0
    v_mov_b32 v119, 0
    v_mov_b32 v120, 0
    v_mov_b32 v121, 0
    v_mov_b32 v122, 0
    v_mov_b32 v123, 0
    v_mov_b32 v124, 0
    v_mov_b32 v125, 0
    v_mov_b32 v126, 0
    v_mov_b32 v127, 0
    s_barrier
    ds_read_b64_tr_b16 v[140:141], v16 offset:0
    ds_read_b64_tr_b16 v[142:143], v16 offset:1024
    ds_read_b128 v[128:131], v19 offset:0
    ds_read_b128 v[132:135], v19 offset:4096
    ds_read_b128 v[136:139], v19 offset:8192
    ds_read_b64_tr_b16 v[156:157], v16 offset:4096
    ds_read_b64_tr_b16 v[158:159], v16 offset:5120
    ds_read_b128 v[144:147], v19 offset:1024
    ds_read_b128 v[148:151], v19 offset:5120
    ds_read_b128 v[152:155], v19 offset:9216
    s_waitcnt lgkmcnt(5)
    v_mfma_f32_32x32x16_bf16 v[64:79], v[128:131], v[140:143], v[64:79]
    ds_read_b64_tr_b16 v[172:173], v16 offset:8192
    ds_read_b64_tr_b16 v[174:175], v16 offset:9216
    v_mfma_f32_4x4x4_16b_bf16 v[112:115], v[140:141], v[140:141], v[112:115]
    v_mfma_f32_4x4x4_16b_bf16 v[120:123], v[22:23], v[140:141], v[120:123]
    v_mfma_f32_32x32x16_bf16 v[80:95], v[132:135], v[140:143], v[80:95]
    ds_read_b128 v[160:163], v19 offset:2048
    ds_read_b128 v[164:167], v19 offset:6144
    v_mfma_f32_4x4x4_16b_bf16 v[116:119], v[142:143], v[142:143], v[116:119]
    v_mfma_f32_4x4x4_16b_bf16 v[124:127], v[22:23], v[142:143], v[124:127]
    v_mfma_f32_32x32x16_bf16 v[96:111], v[136:139], v[140:143], v[96:111]
    ds_read_b128 v[168:171], v19 offset:10240
    s_waitcnt lgkmcnt(5)
    v_mfma_f32_32x32x16_bf16 v[64:79], v[144:147], v[156:159], v[64:79]
    ds_read_b64_tr_b16 v[140:141], v16 offset:12288
    ds_read_b64_tr_b16 v[142:143], v16 offset:13312
    v_mfma_f32_4x4x4_16b_bf16 v[112:115], v[156:157], v[156:157], v[112:115]
    v_mfma_f32_4x4x4_16b_bf16 v[120:123], v[22:23], v[156:157], v[120:123]
    v_mfma_f32_32x32x16_bf16 v[80:95], v[148:151], v[156:159], v[80:95]
    ds_read_b128 v[128:131], v19 offset:3072
    ds_read_b128 v[132:135], v19 offset:7168
    v_mfma_f32_4x4x4_16b_bf16 v[116:119], v[158:159], v[158:159], v[116:119]
    v_mfma_f32_4x4x4_16b_bf16 v[124:127], v[22:23], v[158:159], v[124:127]
    v_mfma_f32_32x32x16_bf16 v[96:111], v[152:155], v[156:159], v[96:111]
    ds_read_b128 v[136:139], v19 offset:11264
    s_waitcnt lgkmcnt(5)
    v_mfma_f32_32x32x16_bf16 v[64:79], v[160:163], v[172:175], v[64:79]
    v_mfma_f32_4x4x4_16b_bf16 v[112:115], v[172:173], v[172:173], v[112:115]
    v_mfma_f32_4x4x4_16b_bf16 v[120:123], v[22:23], v[172:173], v[120:123]
    v_mfma_f32_32x32x16_bf16 v[80:95], v[164:167], v[172:175], v[80:95]
    v_mfma_f32_4x4x4_16b_bf16 v[116:119], v[174:175], v[174:175], v[116:119]
    v_mfma_f32_4x4x4_16b_bf16 v[124:127], v[22:23], v[174:175], v[124:127]
    v_mfma_f32_32x32x16_bf16 v[96:111], v[168:171], v[172:175], v[96:111]
    s_waitcnt vmcnt(0)
    v_lshlrev_b32 v15, 16, v15
    v_cmp_gt_u32 vcc, 96, v0
    s_and_saveexec_b64 s[14:15], vcc
    ds_write_b32 v9, v10
    ds_write_b32 v9, v11 offset:384
    s_mov_b64 exec, s[14:15]
    v_cmp_gt_u32 vcc, 64, v0
    s_and_saveexec_b64 s[14:15], vcc
    ds_write_b32 v18, v14
    ds_write_b32 v18, v15 offset:256
    s_mov_b64 exec, s[14:15]
    s_waitcnt lgkmcnt(0)
    s_barrier
    v_mfma_f32_32x32x16_bf16 v[64:79], v[128:131], v[140:143], v[64:79]
    ds_read_b64_tr_b16 v[156:157], v16 offset:28672
    ds_read_b64_tr_b16 v[158:159], v16 offset:29696
    ds_read_b128 v[144:147], v19 offset:28672
    ds_read_b128 v[148:151], v19 offset:32768
    v_mfma_f32_4x4x4_16b_bf16 v[112:115], v[140:141], v[140:141], v[112:115]
    v_mfma_f32_4x4x4_16b_bf16 v[120:123], v[22:23], v[140:141], v[120:123]
    v_mfma_f32_32x32x16_bf16 v[80:95], v[132:135], v[140:143], v[80:95]
    ds_read_b128 v[152:155], v19 offset:36864
    ds_read_b64_tr_b16 v[172:173], v16 offset:32768
    ds_read_b64_tr_b16 v[174:175], v16 offset:33792
    ds_read_b128 v[160:163], v19 offset:29696
    v_mfma_f32_4x4x4_16b_bf16 v[116:119], v[142:143], v[142:143], v[116:119]
    v_mfma_f32_4x4x4_16b_bf16 v[124:127], v[22:23], v[142:143], v[124:127]
    v_mfma_f32_32x32x16_bf16 v[96:111], v[136:139], v[140:143], v[96:111]
    ds_read_b128 v[164:167], v19 offset:33792
    ds_read_b128 v[168:171], v19 offset:37888
    s_waitcnt lgkmcnt(5)
    v_mfma_f32_32x32x16_bf16 v[64:79], v[144:147], v[156:159], v[64:79]
    ds_read_b64_tr_b16 v[140:141], v16 offset:36864
    ds_read_b64_tr_b16 v[142:143], v16 offset:37888
    v_mfma_f32_4x4x4_16b_bf16 v[112:115], v[156:157], v[156:157], v[112:115]
    v_mfma_f32_4x4x4_16b_bf16 v[120:123], v[22:23], v[156:157], v[120:123]
    v_mfma_f32_32x32x16_bf16 v[80:95], v[148:151], v[156:159], v[80:95]
    ds_read_b128 v[128:131], v19 offset:30720
    ds_read_b128 v[132:135], v19 offset:34816
    v_mfma_f32_4x4x4_16b_bf16 v[116:119], v[158:159], v[158:159], v[116:119]
    v_mfma_f32_4x4x4_16b_bf16 v[124:127], v[22:23], v[158:159], v[124:127]
    v_mfma_f32_32x32x16_bf16 v[96:111], v[152:155], v[156:159], v[96:111]
    ds_read_b128 v[136:139], v19 offset:38912
    s_waitcnt lgkmcnt(5)
    v_mfma_f32_32x32x16_bf16 v[64:79], v[160:163], v[172:175], v[64:79]
    ds_read_b64_tr_b16 v[156:157], v16 offset:40960
    ds_read_b64_tr_b16 v[158:159], v16 offset:41984
    v_mfma_f32_4x4x4_16b_bf16 v[112:115], v[172:173], v[172:173], v[112:115]
    v_mfma_f32_4x4x4_16b_bf16 v[120:123], v[22:23], v[172:173], v[120:123]
    v_mfma_f32_32x32x16_bf16 v[80:95], v[164:167], v[172:175], v[80:95]
    ds_read_b128 v[144:147], v19 offset:31744
    ds_read_b128 v[148:151], v19 offset:35840
    v_mfma_f32_4x4x4_16b_bf16 v[116:119], v[174:175], v[174:175], v[116:119]
    v_mfma_f32_4x4x4_16b_bf16 v[124:127], v[22:23], v[174:175], v[124:127]
    v_mfma_f32_32x32x16_bf16 v[96:111], v[168:171], v[172:175], v[96:111]
    ds_read_b128 v[152:155], v19 offset:39936
    s_waitcnt lgkmcnt(5)
    v_mfma_f32_32x32x16_bf16 v[64:79], v[128:131], v[140:143], v[64:79]
    v_mfma_f32_4x4x4_16b_bf16 v[112:115], v[140:141], v[140:141], v[112:115]
    v_mfma_f32_4x4x4_16b_bf16 v[120:123], v[22:23], v[140:141], v[120:123]
    v_mfma_f32_32x32x16_bf16 v[80:95], v[132:135], v[140:143], v[80:95]
    v_mfma_f32_4x4x4_16b_bf16 v[116:119], v[142:143], v[142:143], v[116:119]
    v_mfma_f32_4x4x4_16b_bf16 v[124:127], v[22:23], v[142:143], v[124:127]
    v_mfma_f32_32x32x16_bf16 v[96:111], v[136:139], v[140:143], v[96:111]
    s_waitcnt lgkmcnt(0)
    s_barrier
    v_mfma_f32_32x32x16_bf16 v[64:79], v[144:147], v[156:159], v[64:79]
    ds_read_b64_tr_b16 v[172:173], v17 offset:0
    ds_read_b64_tr_b16 v[174:175], v17 offset:1024
    ds_read_b128 v[160:163], v20 offset:0
    ds_read_b128 v[164:167], v20 offset:4096
    v_mfma_f32_4x4x4_16b_bf16 v[112:115], v[156:157], v[156:157], v[112:115]
    v_mfma_f32_4x4x4_16b_bf16 v[120:123], v[22:23], v[156:157], v[120:123]
    v_mfma_f32_32x32x16_bf16 v[80:95], v[148:151], v[156:159], v[80:95]
    ds_read_b128 v[168:171], v20 offset:8192
    ds_read_b64_tr_b16 v[140:141], v17 offset:4096
    ds_read_b64_tr_b16 v[142:143], v17 offset:5120
    ds_read_b128 v[128:131], v20 offset:1024
    v_mfma_f32_4x4x4_16b_bf16 v[116:119], v[158:159], v[158:159], v[116:119]
    v_mfma_f32_4x4x4_16b_bf16 v[124:127], v[22:23], v[158:159], v[124:127]
    v_mfma_f32_32x32x16_bf16 v[96:111], v[152:155], v[156:159], v[96:111]
    ds_read_b128 v[132:135], v20 offset:5120
    ds_read_b128 v[136:139], v20 offset:9216
    s_waitcnt lgkmcnt(5)
    v_mfma_f32_32x32x16_bf16 v[64:79], v[160:163], v[172:175], v[64:79]
    ds_read_b64_tr_b16 v[156:157], v17 offset:8192
    ds_read_b64_tr_b16 v[158:159], v17 offset:9216
    v_mfma_f32_4x4x4_16b_bf16 v[112:115], v[172:173], v[172:173], v[112:115]
    v_mfma_f32_4x4x4_16b_bf16 v[120:123], v[22:23], v[172:173], v[120:123]
    v_mfma_f32_32x32x16_bf16 v[80:95], v[164:167], v[172:175], v[80:95]
    ds_read_b128 v[144:147], v20 offset:2048
    ds_read_b128 v[148:151], v20 offset:6144
    v_mfma_f32_4x4x4_16b_bf16 v[116:119], v[174:175], v[174:175], v[116:119]
    v_mfma_f32_4x4x4_16b_bf16 v[124:127], v[22:23], v[174:175], v[124:127]
    v_mfma_f32_32x32x16_bf16 v[96:111], v[168:171], v[172:175], v[96:111]
    ds_read_b128 v[152:155], v20 offset:10240
    s_waitcnt lgkmcnt(5)
    v_mfma_f32_32x32x16_bf16 v[64:79], v[128:131], v[140:143], v[64:79]
    ds_read_b64_tr_b16 v[172:173], v17 offset:12288
    ds_read_b64_tr_b16 v[174:175], v17 offset:13312
    v_mfma_f32_4x4x4_16b_bf16 v[112:115], v[140:141], v[140:141], v[112:115]
    v_mfma_f32_4x4x4_16b_bf16 v[120:123], v[22:23], v[140:141], v[120:123]
    v_mfma_f32_32x32x16_bf16 v[80:95], v[132:135], v[140:143], v[80:95]
    ds_read_b128 v[160:163], v20 offset:3072
    ds_read_b128 v[164:167], v20 offset:7168
    v_mfma_f32_4x4x4_16b_bf16 v[116:119], v[142:143], v[142:143], v[116:119]
    v_mfma_f32_4x4x4_16b_bf16 v[124:127], v[22:23], v[142:143], v[124:127]
    v_mfma_f32_32x32x16_bf16 v[96:111], v[136:139], v[140:143], v[96:111]
    ds_read_b128 v[168:171], v20 offset:11264
    s_waitcnt lgkmcnt(5)
    v_mfma_f32_32x32x16_bf16 v[64:79], v[144:147], v[156:159], v[64:79]
    v_mfma_f32_4x4x4_16b_bf16 v[112:115], v[156:157], v[156:157], v[112:115]
    v_mfma_f32_4x4x4_16b_bf16 v[120:123], v[22:23], v[156:157], v[120:123]
    v_mfma_f32_32x32x16_bf16 v[80:95], v[148:151], v[156:159], v[80:95]
    v_mfma_f32_4x4x4_16b_bf16 v[116:119], v[158:159], v[158:159], v[116:119]
    v_mfma_f32_4x4x4_16b_bf16 v[124:127], v[22:23], v[158:159], v[124:127]
    v_mfma_f32_32x32x16_bf16 v[96:111], v[152:155], v[156:159], v[96:111]
    s_waitcnt lgkmcnt(0)
    s_barrier
    v_mfma_f32_32x32x16_bf16 v[64:79], v[160:163], v[172:175], v[64:79]
    ds_read_b64_tr_b16 v[140:141], v17 offset:28672
    ds_read_b64_tr_b16 v[142:143], v17 offset:29696
    ds_read_b128 v[128:131], v20 offset:28672
    ds_read_b128 v[132:135], v20 offset:32768
    v_mfma_f32_4x4x4_16b_bf16 v[112:115], v[172:173], v[172:173], v[112:115]
    v_mfma_f32_4x4x4_16b_bf16 v[120:123], v[22:23], v[172:173], v[120:123]
    v_mfma_f32_32x32x16_bf16 v[80:95], v[164:167], v[172:175], v[80:95]
    ds_read_b128 v[136:139], v20 offset:36864
    ds_read_b64_tr_b16 v[156:157], v17 offset:32768
    ds_read_b64_tr_b16 v[158:159], v17 offset:33792
    ds_read_b128 v[144:147], v20 offset:29696
    v_mfma_f32_4x4x4_16b_bf16 v[116:119], v[174:175], v[174:175], v[116:119]
    v_mfma_f32_4x4x4_16b_bf16 v[124:127], v[22:23], v[174:175], v[124:127]
    v_mfma_f32_32x32x16_bf16 v[96:111], v[168:171], v[172:175], v[96:111]
    ds_read_b128 v[148:151], v20 offset:33792
    ds_read_b128 v[152:155], v20 offset:37888
    s_waitcnt lgkmcnt(5)
    v_mfma_f32_32x32x16_bf16 v[64:79], v[128:131], v[140:143], v[64:79]
    ds_read_b64_tr_b16 v[172:173], v17 offset:36864
    ds_read_b64_tr_b16 v[174:175], v17 offset:37888
    v_mfma_f32_4x4x4_16b_bf16 v[112:115], v[140:141], v[140:141], v[112:115]
    v_mfma_f32_4x4x4_16b_bf16 v[120:123], v[22:23], v[140:141], v[120:123]
    v_mfma_f32_32x32x16_bf16 v[80:95], v[132:135], v[140:143], v[80:95]
    ds_read_b128 v[160:163], v20 offset:30720
    ds_read_b128 v[164:167], v20 offset:34816
    v_mfma_f32_4x4x4_16b_bf16 v[116:119], v[142:143], v[142:143], v[116:119]
    v_mfma_f32_4x4x4_16b_bf16 v[124:127], v[22:23], v[142:143], v[124:127]
    v_mfma_f32_32x32x16_bf16 v[96:111], v[136:139], v[140:143], v[96:111]
    ds_read_b128 v[168:171], v20 offset:38912
    s_waitcnt lgkmcnt(5)
    v_mfma_f32_32x32x16_bf16 v[64:79], v[144:147], v[156:159], v[64:79]
    ds_read_b64_tr_b16 v[140:141], v17 offset:40960
    ds_read_b64_tr_b16 v[142:143], v17 offset:41984
    v_mfma_f32_4x4x4_16b_bf16 v[112:115], v[156:157], v[156:157], v[112:115]
    v_mfma_f32_4x4x4_16b_bf16 v[120:123], v[22:23], v[156:157], v[120:123]
    v_mfma_f32_32x32x16_bf16 v[80:95], v[148:151], v[156:159], v[80:95]
    ds_read_b128 v[128:131], v20 offset:31744
    ds_read_b128 v[132:135], v20 offset:35840
    v_mfma_f32_4x4x4_16b_bf16 v[116:119], v[158:159], v[158:159], v[116:119]
    v_mfma_f32_4x4x4_16b_bf16 v[124:127], v[22:23], v[158:159], v[124:127]
    v_mfma_f32_32x32x16_bf16 v[96:111], v[152:155], v[156:159], v[96:111]
    ds_read_b128 v[136:139], v20 offset:39936
    s_waitcnt lgkmcnt(5)
    v_mfma_f32_32x32x16_bf16 v[64:79], v[160:163], v[172:175], v[64:79]
    v_mfma_f32_4x4x4_16b_bf16 v[112:115], v[172:173], v[172:173], v[112:115]
    v_mfma_f32_4x4x4_16b_bf16 v[120:123], v[22:23], v[172:173], v[120:123]
    v_mfma_f32_32x32x16_bf16 v[80:95], v[164:167], v[172:175], v[80:95]
    v_mfma_f32_4x4x4_16b_bf16 v[116:119], v[174:175], v[174:175], v[116:119]
    v_mfma_f32_4x4x4_16b_bf16 v[124:127], v[22:23], v[174:175], v[124:127]
    v_mfma_f32_32x32x16_bf16 v[96:111], v[168:171], v[172:175], v[96:111]
    s_waitcnt lgkmcnt(0)
    s_barrier
    v_mfma_f32_32x32x16_bf16 v[64:79], v[128:131], v[140:143], v[64:79]
    ds_read_b64_tr_b16 v[156:157], v16 offset:0
    ds_read_b64_tr_b16 v[158:159], v16 offset:1024
    ds_read_b128 v[144:147], v19 offset:0
    ds_read_b128 v[148:151], v19 offset:4096
    v_mfma_f32_4x4x4_16b_bf16 v[112:115], v[140:141], v[140:141], v[112:115]
    v_mfma_f32_4x4x4_16b_bf16 v[120:123], v[22:23], v[140:141], v[120:123]
    v_mfma_f32_32x32x16_bf16 v[80:95], v[132:135], v[140:143], v[80:95]
    ds_read_b128 v[152:155], v19 offset:8192
    ds_read_b64_tr_b16 v[172:173], v16 offset:4096
    ds_read_b64_tr_b16 v[174:175], v16 offset:5120
    ds_read_b128 v[160:163], v19 offset:1024
    v_mfma_f32_4x4x4_16b_bf16 v[116:119], v[142:143], v[142:143], v[116:119]
    v_mfma_f32_4x4x4_16b_bf16 v[124:127], v[22:23], v[142:143], v[124:127]
    v_mfma_f32_32x32x16_bf16 v[96:111], v[136:139], v[140:143], v[96:111]
    ds_read_b128 v[164:167], v19 offset:5120
    ds_read_b128 v[168:171], v19 offset:9216
    s_waitcnt lgkmcnt(5)
    v_mfma_f32_32x32x16_bf16 v[64:79], v[144:147], v[156:159], v[64:79]
    ds_read_b64_tr_b16 v[140:141], v16 offset:8192
    ds_read_b64_tr_b16 v[142:143], v16 offset:9216
    v_mfma_f32_4x4x4_16b_bf16 v[112:115], v[156:157], v[156:157], v[112:115]
    v_mfma_f32_4x4x4_16b_bf16 v[120:123], v[22:23], v[156:157], v[120:123]
    v_mfma_f32_32x32x16_bf16 v[80:95], v[148:151], v[156:159], v[80:95]
    ds_read_b128 v[128:131], v19 offset:2048
    ds_read_b128 v[132:135], v19 offset:6144
    v_mfma_f32_4x4x4_16b_bf16 v[116:119], v[158:159], v[158:159], v[116:119]
    v_mfma_f32_4x4x4_16b_bf16 v[124:127], v[22:23], v[158:159], v[124:127]
    v_mfma_f32_32x32x16_bf16 v[96:111], v[152:155], v[156:159], v[96:111]
    ds_read_b128 v[136:139], v19 offset:10240
    s_waitcnt lgkmcnt(5)
    v_mfma_f32_32x32x16_bf16 v[64:79], v[160:163], v[172:175], v[64:79]
    ds_read_b64_tr_b16 v[156:157], v16 offset:12288
    ds_read_b64_tr_b16 v[158:159], v16 offset:13312
    v_mfma_f32_4x4x4_16b_bf16 v[112:115], v[172:173], v[172:173], v[112:115]
    v_mfma_f32_4x4x4_16b_bf16 v[120:123], v[22:23], v[172:173], v[120:123]
    v_mfma_f32_32x32x16_bf16 v[80:95], v[164:167], v[172:175], v[80:95]
    ds_read_b128 v[144:147], v19 offset:3072
    ds_read_b128 v[148:151], v19 offset:7168
    v_mfma_f32_4x4x4_16b_bf16 v[116:119], v[174:175], v[174:175], v[116:119]
    v_mfma_f32_4x4x4_16b_bf16 v[124:127], v[22:23], v[174:175], v[124:127]
    v_mfma_f32_32x32x16_bf16 v[96:111], v[168:171], v[172:175], v[96:111]
    ds_read_b128 v[152:155], v19 offset:11264
    s_waitcnt lgkmcnt(5)
    v_mfma_f32_32x32x16_bf16 v[64:79], v[128:131], v[140:143], v[64:79]
    v_mfma_f32_4x4x4_16b_bf16 v[112:115], v[140:141], v[140:141], v[112:115]
    v_mfma_f32_4x4x4_16b_bf16 v[120:123], v[22:23], v[140:141], v[120:123]
    v_mfma_f32_32x32x16_bf16 v[80:95], v[132:135], v[140:143], v[80:95]
    v_mfma_f32_4x4x4_16b_bf16 v[116:119], v[142:143], v[142:143], v[116:119]
    v_mfma_f32_4x4x4_16b_bf16 v[124:127], v[22:23], v[142:143], v[124:127]
    v_mfma_f32_32x32x16_bf16 v[96:111], v[136:139], v[140:143], v[96:111]
    s_waitcnt lgkmcnt(0)
    s_barrier
    v_mfma_f32_32x32x16_bf16 v[64:79], v[144:147], v[156:159], v[64:79]
    ds_read_b64_tr_b16 v[172:173], v16 offset:28672
    ds_read_b64_tr_b16 v[174:175], v16 offset:29696
    ds_read_b128 v[160:163], v19 offset:28672
    ds_read_b128 v[164:167], v19 offset:32768
    v_mfma_f32_4x4x4_16b_bf16 v[112:115], v[156:157], v[156:157], v[112:115]
    v_mfma_f32_4x4x4_16b_bf16 v[120:123], v[22:23], v[156:157], v[120:123]
    v_mfma_f32_32x32x16_bf16 v[80:95], v[148:151], v[156:159], v[80:95]
    ds_read_b128 v[168:171], v19 offset:36864
    ds_read_b64_tr_b16 v[140:141], v16 offset:32768
    ds_read_b64_tr_b16 v[142:143], v16 offset:33792
    ds_read_b128 v[128:131], v19 offset:29696
    v_mfma_f32_4x4x4_16b_bf16 v[116:119], v[158:159], v[158:159], v[116:119]
    v_mfma_f32_4x4x4_16b_bf16 v[124:127], v[22:23], v[158:159], v[124:127]
    v_mfma_f32_32x32x16_bf16 v[96:111], v[152:155], v[156:159], v[96:111]
    ds_read_b128 v[132:135], v19 offset:33792
    ds_read_b128 v[136:139], v19 offset:37888
    s_waitcnt lgkmcnt(5)
    v_mfma_f32_32x32x16_bf16 v[64:79], v[160:163], v[172:175], v[64:79]
    ds_read_b64_tr_b16 v[156:157], v16 offset:36864
    ds_read_b64_tr_b16 v[158:159], v16 offset:37888
    v_mfma_f32_4x4x4_16b_bf16 v[112:115], v[172:173], v[172:173], v[112:115]
    v_mfma_f32_4x4x4_16b_bf16 v[120:123], v[22:23], v[172:173], v[120:123]
    v_mfma_f32_32x32x16_bf16 v[80:95], v[164:167], v[172:175], v[80:95]
    ds_read_b128 v[144:147], v19 offset:30720
    ds_read_b128 v[148:151], v19 offset:34816
    v_mfma_f32_4x4x4_16b_bf16 v[116:119], v[174:175], v[174:175], v[116:119]
    v_mfma_f32_4x4x4_16b_bf16 v[124:127], v[22:23], v[174:175], v[124:127]
    v_mfma_f32_32x32x16_bf16 v[96:111], v[168:171], v[172:175], v[96:111]
    ds_read_b128 v[152:155], v19 offset:38912
    s_waitcnt lgkmcnt(5)
    v_mfma_f32_32x32x16_bf16 v[64:79], v[128:131], v[140:143], v[64:79]
    ds_read_b64_tr_b16 v[172:173], v16 offset:40960
    ds_read_b64_tr_b16 v[174:175], v16 offset:41984
    v_mfma_f32_4x4x4_16b_bf16 v[112:115], v[140:141], v[140:141], v[112:115]
    v_mfma_f32_4x4x4_16b_bf16 v[120:123], v[22:23], v[140:141], v[120:123]
    v_mfma_f32_32x32x16_bf16 v[80:95], v[132:135], v[140:143], v[80:95]
    ds_read_b128 v[160:163], v19 offset:31744
    ds_read_b128 v[164:167], v19 offset:35840
    v_mfma_f32_4x4x4_16b_bf16 v[116:119], v[142:143], v[142:143], v[116:119]
    v_mfma_f32_4x4x4_16b_bf16 v[124:127], v[22:23], v[142:143], v[124:127]
    v_mfma_f32_32x32x16_bf16 v[96:111], v[136:139], v[140:143], v[96:111]
    ds_read_b128 v[168:171], v19 offset:39936
    s_waitcnt lgkmcnt(5)
    v_mfma_f32_32x32x16_bf16 v[64:79], v[144:147], v[156:159], v[64:79]
    v_mfma_f32_4x4x4_16b_bf16 v[112:115], v[156:157], v[156:157], v[112:115]
    v_mfma_f32_4x4x4_16b_bf16 v[120:123], v[22:23], v[156:157], v[120:123]
    v_mfma_f32_32x32x16_bf16 v[80:95], v[148:151], v[156:159], v[80:95]
    v_mfma_f32_4x4x4_16b_bf16 v[116:119], v[158:159], v[158:159], v[116:119]
    v_mfma_f32_4x4x4_16b_bf16 v[124:127], v[22:23], v[158:159], v[124:127]
    v_mfma_f32_32x32x16_bf16 v[96:111], v[152:155], v[156:159], v[96:111]
    s_waitcnt lgkmcnt(0)
    s_barrier
    v_mfma_f32_32x32x16_bf16 v[64:79], v[160:163], v[172:175], v[64:79]
    ds_read_b64_tr_b16 v[140:141], v17 offset:0
    ds_read_b64_tr_b16 v[142:143], v17 offset:1024
    ds_read_b128 v[128:131], v20 offset:0
    ds_read_b128 v[132:135], v20 offset:4096
    v_mfma_f32_4x4x4_16b_bf16 v[112:115], v[172:173], v[172:173], v[112:115]
    v_mfma_f32_4x4x4_16b_bf16 v[120:123], v[22:23], v[172:173], v[120:123]
    v_mfma_f32_32x32x16_bf16 v[80:95], v[164:167], v[172:175], v[80:95]
    ds_read_b128 v[136:139], v20 offset:8192
    ds_read_b64_tr_b16 v[156:157], v17 offset:4096
    ds_read_b64_tr_b16 v[158:159], v17 offset:5120
    ds_read_b128 v[144:147], v20 offset:1024
    v_mfma_f32_4x4x4_16b_bf16 v[116:119], v[174:175], v[174:175], v[116:119]
    v_mfma_f32_4x4x4_16b_bf16 v[124:127], v[22:23], v[174:175], v[124:127]
    v_mfma_f32_32x32x16_bf16 v[96:111], v[168:171], v[172:175], v[96:111]
    ds_read_b128 v[148:151], v20 offset:5120
    ds_read_b128 v[152:155], v20 offset:9216
    s_waitcnt lgkmcnt(5)
    v_mfma_f32_32x32x16_bf16 v[64:79], v[128:131], v[140:143], v[64:79]
    ds_read_b64_tr_b16 v[172:173], v17 offset:8192
    ds_read_b64_tr_b16 v[174:175], v17 offset:9216
    v_mfma_f32_4x4x4_16b_bf16 v[112:115], v[140:141], v[140:141], v[112:115]
    v_mfma_f32_4x4x4_16b_bf16 v[120:123], v[22:23], v[140:141], v[120:123]
    v_mfma_f32_32x32x16_bf16 v[80:95], v[132:135], v[140:143], v[80:95]
    ds_read_b128 v[160:163], v20 offset:2048
    ds_read_b128 v[164:167], v20 offset:6144
    v_mfma_f32_4x4x4_16b_bf16 v[116:119], v[142:143], v[142:143], v[116:119]
    v_mfma_f32_4x4x4_16b_bf16 v[124:127], v[22:23], v[142:143], v[124:127]
    v_mfma_f32_32x32x16_bf16 v[96:111], v[136:139], v[140:143], v[96:111]
    ds_read_b128 v[168:171], v20 offset:10240
    s_waitcnt lgkmcnt(5)
    v_mfma_f32_32x32x16_bf16 v[64:79], v[144:147], v[156:159], v[64:79]
    ds_read_b64_tr_b16 v[140:141], v17 offset:12288
    ds_read_b64_tr_b16 v[142:143], v17 offset:13312
    v_mfma_f32_4x4x4_16b_bf16 v[112:115], v[156:157], v[156:157], v[112:115]
    v_mfma_f32_4x4x4_16b_bf16 v[120:123], v[22:23], v[156:157], v[120:123]
    v_mfma_f32_32x32x16_bf16 v[80:95], v[148:151], v[156:159], v[80:95]
    ds_read_b128 v[128:131], v20 offset:3072
    ds_read_b128 v[132:135], v20 offset:7168
    v_mfma_f32_4x4x4_16b_bf16 v[116:119], v[158:159], v[158:159], v[116:119]
    v_mfma_f32_4x4x4_16b_bf16 v[124:127], v[22:23], v[158:159], v[124:127]
    v_mfma_f32_32x32x16_bf16 v[96:111], v[152:155], v[156:159], v[96:111]
    ds_read_b128 v[136:139], v20 offset:11264
    s_waitcnt lgkmcnt(5)
    v_mfma_f32_32x32x16_bf16 v[64:79], v[160:163], v[172:175], v[64:79]
    v_mfma_f32_4x4x4_16b_bf16 v[112:115], v[172:173], v[172:173], v[112:115]
    v_mfma_f32_4x4x4_16b_bf16 v[120:123], v[22:23], v[172:173], v[120:123]
    v_mfma_f32_32x32x16_bf16 v[80:95], v[164:167], v[172:175], v[80:95]
    v_mfma_f32_4x4x4_16b_bf16 v[116:119], v[174:175], v[174:175], v[116:119]
    v_mfma_f32_4x4x4_16b_bf16 v[124:127], v[22:23], v[174:175], v[124:127]
    v_mfma_f32_32x32x16_bf16 v[96:111], v[168:171], v[172:175], v[96:111]
    s_waitcnt lgkmcnt(0)
    s_barrier
    v_mfma_f32_32x32x16_bf16 v[64:79], v[128:131], v[140:143], v[64:79]
    ds_read_b64_tr_b16 v[156:157], v17 offset:28672
    ds_read_b64_tr_b16 v[158:159], v17 offset:29696
    ds_read_b128 v[144:147], v20 offset:28672
    ds_read_b128 v[148:151], v20 offset:32768
    v_mfma_f32_4x4x4_16b_bf16 v[112:115], v[140:141], v[140:141], v[112:115]
    v_mfma_f32_4x4x4_16b_bf16 v[120:123], v[22:23], v[140:141], v[120:123]
    v_mfma_f32_32x32x16_bf16 v[80:95], v[132:135], v[140:143], v[80:95]
    ds_read_b128 v[152:155], v20 offset:36864
    ds_read_b64_tr_b16 v[172:173], v17 offset:32768
    ds_read_b64_tr_b16 v[174:175], v17 offset:33792
    ds_read_b128 v[160:163], v20 offset:29696
    v_mfma_f32_4x4x4_16b_bf16 v[116:119], v[142:143], v[142:143], v[116:119]
    v_mfma_f32_4x4x4_16b_bf16 v[124:127], v[22:23], v[142:143], v[124:127]
    v_mfma_f32_32x32x16_bf16 v[96:111], v[136:139], v[140:143], v[96:111]
    ds_read_b128 v[164:167], v20 offset:33792
    ds_read_b128 v[168:171], v20 offset:37888
    s_waitcnt lgkmcnt(5)
    v_mfma_f32_32x32x16_bf16 v[64:79], v[144:147], v[156:159], v[64:79]
    ds_read_b64_tr_b16 v[140:141], v17 offset:36864
    ds_read_b64_tr_b16 v[142:143], v17 offset:37888
    v_mfma_f32_4x4x4_16b_bf16 v[112:115], v[156:157], v[156:157], v[112:115]
    v_mfma_f32_4x4x4_16b_bf16 v[120:123], v[22:23], v[156:157], v[120:123]
    v_mfma_f32_32x32x16_bf16 v[80:95], v[148:151], v[156:159], v[80:95]
    ds_read_b128 v[128:131], v20 offset:30720
    ds_read_b128 v[132:135], v20 offset:34816
    v_mfma_f32_4x4x4_16b_bf16 v[116:119], v[158:159], v[158:159], v[116:119]
    v_mfma_f32_4x4x4_16b_bf16 v[124:127], v[22:23], v[158:159], v[124:127]
    v_mfma_f32_32x32x16_bf16 v[96:111], v[152:155], v[156:159], v[96:111]
    ds_read_b128 v[136:139], v20 offset:38912
    s_waitcnt lgkmcnt(5)
    v_mfma_f32_32x32x16_bf16 v[64:79], v[160:163], v[172:175], v[64:79]
    ds_read_b64_tr_b16 v[156:157], v17 offset:40960
    ds_read_b64_tr_b16 v[158:159], v17 offset:41984
    v_mfma_f32_4x4x4_16b_bf16 v[112:115], v[172:173], v[172:173], v[112:115]
    v_mfma_f32_4x4x4_16b_bf16 v[120:123], v[22:23], v[172:173], v[120:123]
    v_mfma_f32_32x32x16_bf16 v[80:95], v[164:167], v[172:175], v[80:95]
    ds_read_b128 v[144:147], v20 offset:31744
    ds_read_b128 v[148:151], v20 offset:35840
    v_mfma_f32_4x4x4_16b_bf16 v[116:119], v[174:175], v[174:175], v[116:119]
    v_mfma_f32_4x4x4_16b_bf16 v[124:127], v[22:23], v[174:175], v[124:127]
    v_mfma_f32_32x32x16_bf16 v[96:111], v[168:171], v[172:175], v[96:111]
    ds_read_b128 v[152:155], v20 offset:39936
    s_waitcnt lgkmcnt(5)
    v_mfma_f32_32x32x16_bf16 v[64:79], v[128:131], v[140:143], v[64:79]
    v_mfma_f32_4x4x4_16b_bf16 v[112:115], v[140:141], v[140:141], v[112:115]
    v_mfma_f32_4x4x4_16b_bf16 v[120:123], v[22:23], v[140:141], v[120:123]
    v_mfma_f32_32x32x16_bf16 v[80:95], v[132:135], v[140:143], v[80:95]
    v_mfma_f32_4x4x4_16b_bf16 v[116:119], v[142:143], v[142:143], v[116:119]
    v_mfma_f32_4x4x4_16b_bf16 v[124:127], v[22:23], v[142:143], v[124:127]
    v_mfma_f32_32x32x16_bf16 v[96:111], v[136:139], v[140:143], v[96:111]
    s_waitcnt lgkmcnt(0)
    s_barrier
    v_mfma_f32_32x32x16_bf16 v[64:79], v[144:147], v[156:159], v[64:79]
    v_mfma_f32_4x4x4_16b_bf16 v[112:115], v[156:157], v[156:157], v[112:115]
    v_mfma_f32_4x4x4_16b_bf16 v[120:123], v[22:23], v[156:157], v[120:123]
    v_mfma_f32_32x32x16_bf16 v[80:95], v[148:151], v[156:159], v[80:95]
    v_mfma_f32_4x4x4_16b_bf16 v[116:119], v[158:159], v[158:159], v[116:119]
    v_mfma_f32_4x4x4_16b_bf16 v[124:127], v[22:23], v[158:159], v[124:127]
    v_mfma_f32_32x32x16_bf16 v[96:111], v[152:155], v[156:159], v[96:111]
    v_and_b32 v6, 3, v1
    v_cmp_eq_u32 s[12:13], 1, v6
    v_cmp_eq_u32 s[14:15], 2, v6
    v_cmp_eq_u32 s[16:17], 3, v6
    v_lshrrev_b32 v6, 5, v1
    v_lshlrev_b32 v6, 4, v6
    v_add_u32 v6, 114688, v6
    ds_read_b128 v[28:31], v6 offset:0
    ds_read_b128 v[44:47], v6 offset:384
    ds_read_b128 v[32:35], v6 offset:32
    ds_read_b128 v[48:51], v6 offset:416
    ds_read_b128 v[36:39], v6 offset:64
    ds_read_b128 v[52:55], v6 offset:448
    ds_read_b128 v[40:43], v6 offset:96
    ds_read_b128 v[56:59], v6 offset:480
    v_add_f32 v112, v112, v116
    v_add_f32 v113, v113, v117
    v_add_f32 v114, v114, v118
    v_add_f32 v115, v115, v119
    v_add_f32 v120, v120, v124
    v_cndmask_b32 v112, v112, v113, s[12:13]
    v_cndmask_b32 v112, v112, v114, s[14:15]
    v_cndmask_b32 v112, v112, v115, s[16:17]
    v_mov_b32 v25, v120
    v_mov_b32 v24, v112
    s_nop 1
    v_permlane32_swap_b32 v25, v120
    v_permlane32_swap_b32 v24, v112
    s_nop 1
    v_add_f32 v25, v25, v120
    v_add_f32 v24, v24, v112
    v_mul_f32 v25, 0x3b000000, v25
    v_mul_f32 v24, 0x3b000000, v24
    v_fma_f32 v24, -v25, v25, v24
    v_max_f32 v24, 0, v24
    v_add_f32 v24, 0x3727c5ac, v24
    v_rsq_f32 v24, v24
    s_lshl_b32 s12, s4, 2
    v_mul_f32 v26, -v25, v24
    s_add_u32 s12, s12, s26
    s_mul_i32 s12, s12, 88
    v_mov_b32 v25, v24
    v_mov_b32 v27, v26
    s_mul_i32 s13, s5, 6
    s_add_u32 s12, s12, s13
    s_lshl_b32 s12, s12, 10
    s_add_u32 s12, s12, 16777216
    s_waitcnt lgkmcnt(0)
    ds_read_b128 v[144:147], v6 offset:128
    ds_read_b128 v[160:163], v6 offset:512
    ds_read_b128 v[148:151], v6 offset:160
    ds_read_b128 v[164:167], v6 offset:544
    ds_read_b128 v[152:155], v6 offset:192
    ds_read_b128 v[168:171], v6 offset:576
    ds_read_b128 v[156:159], v6 offset:224
    ds_read_b128 v[172:175], v6 offset:608
    v_pk_fma_f32 v[44:45], v[26:27], v[28:29], v[44:45]
    v_pk_fma_f32 v[46:47], v[26:27], v[30:31], v[46:47]
    v_pk_fma_f32 v[48:49], v[26:27], v[32:33], v[48:49]
    v_pk_fma_f32 v[50:51], v[26:27], v[34:35], v[50:51]
    v_pk_fma_f32 v[52:53], v[26:27], v[36:37], v[52:53]
    v_pk_fma_f32 v[54:55], v[26:27], v[38:39], v[54:55]
    v_pk_fma_f32 v[56:57], v[26:27], v[40:41], v[56:57]
    v_pk_fma_f32 v[58:59], v[26:27], v[42:43], v[58:59]
    v_pk_fma_f32 v[44:45], v[24:25], v[64:65], v[44:45]
    v_pk_fma_f32 v[46:47], v[24:25], v[66:67], v[46:47]
    v_pk_fma_f32 v[48:49], v[24:25], v[68:69], v[48:49]
    v_pk_fma_f32 v[50:51], v[24:25], v[70:71], v[50:51]
    v_pk_fma_f32 v[52:53], v[24:25], v[72:73], v[52:53]
    v_pk_fma_f32 v[54:55], v[24:25], v[74:75], v[54:55]
    v_pk_fma_f32 v[56:57], v[24:25], v[76:77], v[56:57]
    v_pk_fma_f32 v[58:59], v[24:25], v[78:79], v[58:59]
    v_max_f32 v44, 0, v44
    v_max_f32 v45, 0, v45
    v_max_f32 v46, 0, v46
    v_max_f32 v47, 0, v47
    v_max_f32 v48, 0, v48
    v_max_f32 v49, 0, v49
    v_max_f32 v50, 0, v50
    v_max_f32 v51, 0, v51
    v_max_f32 v52, 0, v52
    v_max_f32 v53, 0, v53
    v_max_f32 v54, 0, v54
    v_max_f32 v55, 0, v55
    v_max_f32 v56, 0, v56
    v_max_f32 v57, 0, v57
    v_max_f32 v58, 0, v58
    v_max_f32 v59, 0, v59
    v_pk_mul_f32 v[44:45], v[44:45], v[44:45]
    v_pk_mul_f32 v[46:47], v[46:47], v[46:47]
    v_pk_mul_f32 v[48:49], v[48:49], v[48:49]
    v_pk_mul_f32 v[50:51], v[50:51], v[50:51]
    v_pk_mul_f32 v[52:53], v[52:53], v[52:53]
    v_pk_mul_f32 v[54:55], v[54:55], v[54:55]
    v_pk_mul_f32 v[56:57], v[56:57], v[56:57]
    v_pk_mul_f32 v[58:59], v[58:59], v[58:59]
    v_cvt_pk_bf16_f32 v64, v44, v45
    v_cvt_pk_bf16_f32 v65, v46, v47
    v_cvt_pk_bf16_f32 v66, v48, v49
    v_cvt_pk_bf16_f32 v67, v50, v51
    v_cvt_pk_bf16_f32 v68, v52, v53
    v_cvt_pk_bf16_f32 v69, v54, v55
    v_cvt_pk_bf16_f32 v70, v56, v57
    v_cvt_pk_bf16_f32 v71, v58, v59
    s_nop 1
    v_permlane32_swap_b32 v64, v66
    v_permlane32_swap_b32 v65, v67
    v_permlane32_swap_b32 v68, v70
    v_permlane32_swap_b32 v69, v71
    buffer_store_dwordx4 v[64:67], v4, s[8:11], s12 offen sc1
    buffer_store_dwordx4 v[68:71], v4, s[8:11], s12 offen offset:1024 sc1
    s_add_u32 s12, s12, 2048
    s_cmp_eq_u32 s5, 14
    s_cbranch_scc0 cd_more
    s_waitcnt lgkmcnt(0)
    v_mov_b32 v28, 0
    v_mov_b32 v29, 0
    v_mov_b32 v30, 0
    v_mov_b32 v31, 0
    buffer_store_dwordx4 v[28:31], v4, s[8:11], s12 offen sc1
    buffer_store_dwordx4 v[28:31], v4, s[8:11], s12 offen offset:1024 sc1
    s_branch cd_cmp2
cd_more:
    s_waitcnt lgkmcnt(0)
    ds_read_b128 v[28:31], v6 offset:256
    ds_read_b128 v[44:47], v6 offset:640
    ds_read_b128 v[32:35], v6 offset:288
    ds_read_b128 v[48:51], v6 offset:672
    ds_read_b128 v[36:39], v6 offset:320
    ds_read_b128 v[52:55], v6 offset:704
    ds_read_b128 v[40:43], v6 offset:352
    ds_read_b128 v[56:59], v6 offset:736
    v_pk_fma_f32 v[160:161], v[26:27], v[144:145], v[160:161]
    v_pk_fma_f32 v[162:163], v[26:27], v[146:147], v[162:163]
    v_pk_fma_f32 v[164:165], v[26:27], v[148:149], v[164:165]
    v_pk_fma_f32 v[166:167], v[26:27], v[150:151], v[166:167]
    v_pk_fma_f32 v[168:169], v[26:27], v[152:153], v[168:169]
    v_pk_fma_f32 v[170:171], v[26:27], v[154:155], v[170:171]
    v_pk_fma_f32 v[172:173], v[26:27], v[156:157], v[172:173]
    v_pk_fma_f32 v[174:175], v[26:27], v[158:159], v[174:175]
    v_pk_fma_f32 v[160:161], v[24:25], v[80:81], v[160:161]
    v_pk_fma_f32 v[162:163], v[24:25], v[82:83], v[162:163]
    v_pk_fma_f32 v[164:165], v[24:25], v[84:85], v[164:165]
    v_pk_fma_f32 v[166:167], v[24:25], v[86:87], v[166:167]
    v_pk_fma_f32 v[168:169], v[24:25], v[88:89], v[168:169]
    v_pk_fma_f32 v[170:171], v[24:25], v[90:91], v[170:171]
    v_pk_fma_f32 v[172:173], v[24:25], v[92:93], v[172:173]
    v_pk_fma_f32 v[174:175], v[24:25], v[94:95], v[174:175]
    v_max_f32 v160, 0, v160
    v_max_f32 v161, 0, v161
    v_max_f32 v162, 0, v162
    v_max_f32 v163, 0, v163
    v_max_f32 v164, 0, v164
    v_max_f32 v165, 0, v165
    v_max_f32 v166, 0, v166
    v_max_f32 v167, 0, v167
    v_max_f32 v168, 0, v168
    v_max_f32 v169, 0, v169
    v_max_f32 v170, 0, v170
    v_max_f32 v171, 0, v171
    v_max_f32 v172, 0, v172
    v_max_f32 v173, 0, v173
    v_max_f32 v174, 0, v174
    v_max_f32 v175, 0, v175
    v_pk_mul_f32 v[160:161], v[160:161], v[160:161]
    v_pk_mul_f32 v[162:163], v[162:163], v[162:163]
    v_pk_mul_f32 v[164:165], v[164:165], v[164:165]
    v_pk_mul_f32 v[166:167], v[166:167], v[166:167]
    v_pk_mul_f32 v[168:169], v[168:169], v[168:169]
    v_pk_mul_f32 v[170:171], v[170:171], v[170:171]
    v_pk_mul_f32 v[172:173], v[172:173], v[172:173]
    v_pk_mul_f32 v[174:175], v[174:175], v[174:175]
    v_cvt_pk_bf16_f32 v80, v160, v161
    v_cvt_pk_bf16_f32 v81, v162, v163
    v_cvt_pk_bf16_f32 v82, v164, v165
    v_cvt_pk_bf16_f32 v83, v166, v167
    v_cvt_pk_bf16_f32 v84, v168, v169
    v_cvt_pk_bf16_f32 v85, v170, v171
    v_cvt_pk_bf16_f32 v86, v172, v173
    v_cvt_pk_bf16_f32 v87, v174, v175
    s_nop 1
    v_permlane32_swap_b32 v80, v82
    v_permlane32_swap_b32 v81, v83
    v_permlane32_swap_b32 v84, v86
    v_permlane32_swap_b32 v85, v87
    buffer_store_dwordx4 v[80:83], v4, s[8:11], s12 offen sc1
    buffer_store_dwordx4 v[84:87], v4, s[8:11], s12 offen offset:1024 sc1
    s_add_u32 s12, s12, 2048
    s_waitcnt lgkmcnt(0)
    v_pk_fma_f32 v[44:45], v[26:27], v[28:29], v[44:45]
    v_pk_fma_f32 v[46:47], v[26:27], v[30:31], v[46:47]
    v_pk_fma_f32 v[48:49], v[26:27], v[32:33], v[48:49]
    v_pk_fma_f32 v[50:51], v[26:27], v[34:35], v[50:51]
    v_pk_fma_f32 v[52:53], v[26:27], v[36:37], v[52:53]
    v_pk_fma_f32 v[54:55], v[26:27], v[38:39], v[54:55]
    v_pk_fma_f32 v[56:57], v[26:27], v[40:41], v[56:57]
    v_pk_fma_f32 v[58:59], v[26:27], v[42:43], v[58:59]
    v_pk_fma_f32 v[44:45], v[24:25], v[96:97], v[44:45]
    v_pk_fma_f32 v[46:47], v[24:25], v[98:99], v[46:47]
    v_pk_fma_f32 v[48:49], v[24:25], v[100:101], v[48:49]
    v_pk_fma_f32 v[50:51], v[24:25], v[102:103], v[50:51]
    v_pk_fma_f32 v[52:53], v[24:25], v[104:105], v[52:53]
    v_pk_fma_f32 v[54:55], v[24:25], v[106:107], v[54:55]
    v_pk_fma_f32 v[56:57], v[24:25], v[108:109], v[56:57]
    v_pk_fma_f32 v[58:59], v[24:25], v[110:111], v[58:59]
    v_max_f32 v44, 0, v44
    v_max_f32 v45, 0, v45
    v_max_f32 v46, 0, v46
    v_max_f32 v47, 0, v47
    v_max_f32 v48, 0, v48
    v_max_f32 v49, 0, v49
    v_max_f32 v50, 0, v50
    v_max_f32 v51, 0, v51
    v_max_f32 v52, 0, v52
    v_max_f32 v53, 0, v53
    v_max_f32 v54, 0, v54
    v_max_f32 v55, 0, v55
    v_max_f32 v56, 0, v56
    v_max_f32 v57, 0, v57
    v_max_f32 v58, 0, v58
    v_max_f32 v59, 0, v59
    v_pk_mul_f32 v[44:45], v[44:45], v[44:45]
    v_pk_mul_f32 v[46:47], v[46:47], v[46:47]
    v_pk_mul_f32 v[48:49], v[48:49], v[48:49]
    v_pk_mul_f32 v[50:51], v[50:51], v[50:51]
    v_pk_mul_f32 v[52:53], v[52:53], v[52:53]
    v_pk_mul_f32 v[54:55], v[54:55], v[54:55]
    v_pk_mul_f32 v[56:57], v[56:57], v[56:57]
    v_pk_mul_f32 v[58:59], v[58:59], v[58:59]
    v_cvt_pk_bf16_f32 v96, v44, v45
    v_cvt_pk_bf16_f32 v97, v46, v47
    v_cvt_pk_bf16_f32 v98, v48, v49
    v_cvt_pk_bf16_f32 v99, v50, v51
    v_cvt_pk_bf16_f32 v100, v52, v53
    v_cvt_pk_bf16_f32 v101, v54, v55
    v_cvt_pk_bf16_f32 v102, v56, v57
    v_cvt_pk_bf16_f32 v103, v58, v59
    s_nop 1
    v_permlane32_swap_b32 v96, v98
    v_permlane32_swap_b32 v97, v99
    v_permlane32_swap_b32 v100, v102
    v_permlane32_swap_b32 v101, v103
    buffer_store_dwordx4 v[96:99], v4, s[8:11], s12 offen sc1
    buffer_store_dwordx4 v[100:103], v4, s[8:11], s12 offen offset:1024 sc1
    s_add_u32 s12, s12, 2048
cd_cmp2:
    s_and_b32 s27, s26, 1
    s_lshr_b32 s28, s26, 1
    v_and_b32 v6, 15, v1
    v_lshrrev_b32 v7, 2, v6
    v_and_b32 v6, 3, v6
    v_lshrrev_b32 v12, 5, v1
    v_lshl_add_u32 v12, v12, 3, v7
    v_lshlrev_b32 v12, 7, v12
    v_bfe_u32 v13, v1, 4, 1
    v_lshlrev_b32 v13, 1, v13
    s_lshl_b32 s12, s27, 2
    v_add_u32 v13, s12, v13
    v_lshrrev_b32 v16, 1, v6
    v_add_u32 v13, v13, v16
    v_lshrrev_b32 v7, 1, v7
    v_lshlrev_b32 v7, 2, v7
    v_xor_b32 v13, v13, v7
    v_lshl_add_u32 v12, v13, 4, v12
    v_and_b32 v6, 1, v6
    v_lshl_add_u32 v16, v6, 3, v12
    v_add_u32 v17, 65536, v16
    s_lshl_b32 s12, s28, 13
    s_add_u32 s12, s12, 98304
    v_add_u32 v18, s12, v4
    s_waitcnt vmcnt(0)
    s_barrier
    v_mov_b32 v64, 0
    v_mov_b32 v65, 0
    v_mov_b32 v66, 0
    v_mov_b32 v67, 0
    v_mov_b32 v68, 0
    v_mov_b32 v69, 0
    v_mov_b32 v70, 0
    v_mov_b32 v71, 0
    v_mov_b32 v72, 0
    v_mov_b32 v73, 0
    v_mov_b32 v74, 0
    v_mov_b32 v75, 0
    v_mov_b32 v76, 0
    v_mov_b32 v77, 0
    v_mov_b32 v78, 0
    v_mov_b32 v79, 0
    v_and_b32 v6, 15, v1
    v_lshrrev_b32 v7, 2, v6
    v_and_b32 v6, 3, v6
    v_lshrrev_b32 v12, 5, v1
    v_lshl_add_u32 v13, v12, 2, v7
    s_lshl_b32 s12, s27, 5
    v_add_u32 v13, s12, v13
    v_lshlrev_b32 v13, 7, v13
    v_bfe_u32 v14, v1, 4, 1
    v_lshlrev_b32 v14, 1, v14
    s_lshl_b32 s12, s28, 2
    v_add_u32 v14, s12, v14
    v_lshrrev_b32 v15, 1, v6
    v_add_u32 v14, v14, v15
    v_lshrrev_b32 v7, 1, v7
    v_lshlrev_b32 v7, 2, v7
    v_xor_b32 v14, v14, v7
    v_lshl_add_u32 v13, v14, 4, v13
    v_and_b32 v6, 1, v6
    v_lshl_add_u32 v13, v6, 3, v13
    v_add_u32 v13, 147456, v13
    v_lshlrev_b32 v14, 4, v12
    s_lshl_b32 s12, s27, 7
    s_add_u32 s12, s12, 155648
    v_add_u32 v14, s12, v14
    ds_read_b64_tr_b16 v[24:25], v13 offset:0
    ds_read_b128 v[32:35], v14 offset:0
    ds_read_b128 v[48:51], v14 offset:256
    ds_read_b64_tr_b16 v[26:27], v13 offset:1024
    ds_read_b128 v[36:39], v14 offset:32
    ds_read_b128 v[52:55], v14 offset:288
    ds_read_b64_tr_b16 v[28:29], v13 offset:2048
    ds_read_b128 v[40:43], v14 offset:64
    ds_read_b128 v[56:59], v14 offset:320
    ds_read_b64_tr_b16 v[30:31], v13 offset:3072
    ds_read_b128 v[44:47], v14 offset:96
    ds_read_b128 v[60:63], v14 offset:352
    v_and_b32 v5, 31, v1
    v_lshlrev_b32 v20, 10, v5
    v_lshl_add_u32 v20, v12, 4, v20
    s_lshl_b32 s12, s52, 1
    s_add_u32 s12, s12, s28
    s_lshl_b32 s12, s12, 15
    s_lshl_b32 s13, s53, 1
    s_add_u32 s13, s13, s27
    s_lshl_b32 s13, s13, 6
    s_add_u32 s12, s12, s13
    v_add_u32 v20, s12, v20
    s_waitcnt lgkmcnt(0)
    v_lshlrev_b32 v8, 16, v24
    v_and_b32 v9, 0xffff0000, v24
    v_lshlrev_b32 v10, 16, v25
    v_and_b32 v11, 0xffff0000, v25
    v_fma_f32 v48, v48, v32, v8
    v_fma_f32 v49, v49, v33, v9
    v_fma_f32 v50, v50, v34, v10
    v_fma_f32 v51, v51, v35, v11
    v_lshlrev_b32 v8, 16, v26
    v_and_b32 v9, 0xffff0000, v26
    v_lshlrev_b32 v10, 16, v27
    v_and_b32 v11, 0xffff0000, v27
    v_fma_f32 v52, v52, v36, v8
    v_fma_f32 v53, v53, v37, v9
    v_fma_f32 v54, v54, v38, v10
    v_fma_f32 v55, v55, v39, v11
    v_lshlrev_b32 v8, 16, v28
    v_and_b32 v9, 0xffff0000, v28
    v_lshlrev_b32 v10, 16, v29
    v_and_b32 v11, 0xffff0000, v29
    v_fma_f32 v56, v56, v40, v8
    v_fma_f32 v57, v57, v41, v9
    v_fma_f32 v58, v58, v42, v10
    v_fma_f32 v59, v59, v43, v11
    v_lshlrev_b32 v8, 16, v30
    v_and_b32 v9, 0xffff0000, v30
    v_lshlrev_b32 v10, 16, v31
    v_and_b32 v11, 0xffff0000, v31
    v_fma_f32 v60, v60, v44, v8
    v_fma_f32 v61, v61, v45, v9
    v_fma_f32 v62, v62, v46, v10
    v_fma_f32 v63, v63, v47, v11
    s_barrier
    ds_read_b64_tr_b16 v[80:81], v16 offset:0
    ds_read_b64_tr_b16 v[82:83], v16 offset:512
    ds_read_b128 v[84:87], v18 offset:0
    ds_read_b64_tr_b16 v[88:89], v16 offset:2048
    ds_read_b64_tr_b16 v[90:91], v16 offset:2560
    ds_read_b128 v[92:95], v18 offset:1024
    ds_read_b64_tr_b16 v[96:97], v16 offset:4096
    ds_read_b64_tr_b16 v[98:99], v16 offset:4608
    ds_read_b128 v[100:103], v18 offset:2048
    ds_read_b64_tr_b16 v[104:105], v16 offset:6144
    ds_read_b64_tr_b16 v[106:107], v16 offset:6656
    ds_read_b128 v[108:111], v18 offset:3072
    ds_read_b64_tr_b16 v[112:113], v16 offset:8192
    ds_read_b64_tr_b16 v[114:115], v16 offset:8704
    ds_read_b128 v[116:119], v18 offset:4096
    s_waitcnt lgkmcnt(12)
    v_mfma_f32_32x32x16_bf16 v[64:79], v[80:83], v[84:87], v[64:79]
    ds_read_b64_tr_b16 v[80:81], v16 offset:10240
    ds_read_b64_tr_b16 v[82:83], v16 offset:10752
    ds_read_b128 v[84:87], v18 offset:5120
    s_waitcnt lgkmcnt(12)
    v_mfma_f32_32x32x16_bf16 v[64:79], v[88:91], v[92:95], v[64:79]
    ds_read_b64_tr_b16 v[88:89], v16 offset:12288
    ds_read_b64_tr_b16 v[90:91], v16 offset:12800
    ds_read_b128 v[92:95], v18 offset:6144
    s_waitcnt lgkmcnt(12)
    v_mfma_f32_32x32x16_bf16 v[64:79], v[96:99], v[100:103], v[64:79]
    ds_read_b64_tr_b16 v[96:97], v16 offset:14336
    ds_read_b64_tr_b16 v[98:99], v16 offset:14848
    ds_read_b128 v[100:103], v18 offset:7168
    s_waitcnt lgkmcnt(12)
    v_mfma_f32_32x32x16_bf16 v[64:79], v[104:107], v[108:111], v[64:79]
    s_waitcnt lgkmcnt(9)
    v_mfma_f32_32x32x16_bf16 v[64:79], v[112:115], v[116:119], v[64:79]
    s_waitcnt lgkmcnt(6)
    v_mfma_f32_32x32x16_bf16 v[64:79], v[80:83], v[84:87], v[64:79]
    s_waitcnt lgkmcnt(3)
    v_mfma_f32_32x32x16_bf16 v[64:79], v[88:91], v[92:95], v[64:79]
    s_waitcnt lgkmcnt(0)
    s_barrier
    ds_read_b64_tr_b16 v[104:105], v16 offset:16384
    ds_read_b64_tr_b16 v[106:107], v16 offset:16896
    ds_read_b128 v[108:111], v18 offset:16384
    ds_read_b64_tr_b16 v[112:113], v16 offset:18432
    ds_read_b64_tr_b16 v[114:115], v16 offset:18944
    ds_read_b128 v[116:119], v18 offset:17408
    ds_read_b64_tr_b16 v[80:81], v16 offset:20480
    ds_read_b64_tr_b16 v[82:83], v16 offset:20992
    ds_read_b128 v[84:87], v18 offset:18432
    ds_read_b64_tr_b16 v[88:89], v16 offset:22528
    ds_read_b64_tr_b16 v[90:91], v16 offset:23040
    ds_read_b128 v[92:95], v18 offset:19456
    v_mfma_f32_32x32x16_bf16 v[64:79], v[96:99], v[100:103], v[64:79]
    ds_read_b64_tr_b16 v[96:97], v16 offset:24576
    ds_read_b64_tr_b16 v[98:99], v16 offset:25088
    ds_read_b128 v[100:103], v18 offset:20480
    s_waitcnt lgkmcnt(12)
    v_mfma_f32_32x32x16_bf16 v[64:79], v[104:107], v[108:111], v[64:79]
    ds_read_b64_tr_b16 v[104:105], v16 offset:26624
    ds_read_b64_tr_b16 v[106:107], v16 offset:27136
    ds_read_b128 v[108:111], v18 offset:21504
    s_waitcnt lgkmcnt(12)
    v_mfma_f32_32x32x16_bf16 v[64:79], v[112:115], v[116:119], v[64:79]
    ds_read_b64_tr_b16 v[112:113], v16 offset:28672
    ds_read_b64_tr_b16 v[114:115], v16 offset:29184
    ds_read_b128 v[116:119], v18 offset:22528
    s_waitcnt lgkmcnt(12)
    v_mfma_f32_32x32x16_bf16 v[64:79], v[80:83], v[84:87], v[64:79]
    ds_read_b64_tr_b16 v[80:81], v16 offset:30720
    ds_read_b64_tr_b16 v[82:83], v16 offset:31232
    ds_read_b128 v[84:87], v18 offset:23552
    s_waitcnt lgkmcnt(12)
    v_mfma_f32_32x32x16_bf16 v[64:79], v[88:91], v[92:95], v[64:79]
    s_waitcnt lgkmcnt(9)
    v_mfma_f32_32x32x16_bf16 v[64:79], v[96:99], v[100:103], v[64:79]
    s_waitcnt lgkmcnt(6)
    v_mfma_f32_32x32x16_bf16 v[64:79], v[104:107], v[108:111], v[64:79]
    s_waitcnt lgkmcnt(3)
    v_mfma_f32_32x32x16_bf16 v[64:79], v[112:115], v[116:119], v[64:79]
    s_waitcnt lgkmcnt(0)
    s_barrier
    ds_read_b64_tr_b16 v[88:89], v16 offset:32768
    ds_read_b64_tr_b16 v[90:91], v16 offset:33280
    ds_read_b128 v[92:95], v18 offset:32768
    ds_read_b64_tr_b16 v[96:97], v16 offset:34816
    ds_read_b64_tr_b16 v[98:99], v16 offset:35328
    ds_read_b128 v[100:103], v18 offset:33792
    ds_read_b64_tr_b16 v[104:105], v16 offset:36864
    ds_read_b64_tr_b16 v[106:107], v16 offset:37376
    ds_read_b128 v[108:111], v18 offset:34816
    ds_read_b64_tr_b16 v[112:113], v16 offset:38912
    ds_read_b64_tr_b16 v[114:115], v16 offset:39424
    ds_read_b128 v[116:119], v18 offset:35840
    v_mfma_f32_32x32x16_bf16 v[64:79], v[80:83], v[84:87], v[64:79]
    ds_read_b64_tr_b16 v[80:81], v16 offset:40960
    ds_read_b64_tr_b16 v[82:83], v16 offset:41472
    ds_read_b128 v[84:87], v18 offset:36864
    s_waitcnt lgkmcnt(12)
    v_mfma_f32_32x32x16_bf16 v[64:79], v[88:91], v[92:95], v[64:79]
    ds_read_b64_tr_b16 v[88:89], v16 offset:43008
    ds_read_b64_tr_b16 v[90:91], v16 offset:43520
    ds_read_b128 v[92:95], v18 offset:37888
    s_waitcnt lgkmcnt(12)
    v_mfma_f32_32x32x16_bf16 v[64:79], v[96:99], v[100:103], v[64:79]
    ds_read_b64_tr_b16 v[96:97], v16 offset:45056
    ds_read_b64_tr_b16 v[98:99], v16 offset:45568
    ds_read_b128 v[100:103], v18 offset:38912
    s_waitcnt lgkmcnt(12)
    v_mfma_f32_32x32x16_bf16 v[64:79], v[104:107], v[108:111], v[64:79]
    ds_read_b64_tr_b16 v[104:105], v16 offset:47104
    ds_read_b64_tr_b16 v[106:107], v16 offset:47616
    ds_read_b128 v[108:111], v18 offset:39936
    s_waitcnt lgkmcnt(12)
    v_mfma_f32_32x32x16_bf16 v[64:79], v[112:115], v[116:119], v[64:79]
    s_waitcnt lgkmcnt(9)
    v_mfma_f32_32x32x16_bf16 v[64:79], v[80:83], v[84:87], v[64:79]
    s_waitcnt lgkmcnt(6)
    v_mfma_f32_32x32x16_bf16 v[64:79], v[88:91], v[92:95], v[64:79]
    s_waitcnt lgkmcnt(3)
    v_mfma_f32_32x32x16_bf16 v[64:79], v[96:99], v[100:103], v[64:79]
    s_waitcnt lgkmcnt(0)
    s_barrier
    ds_read_b64_tr_b16 v[112:113], v16 offset:49152
    ds_read_b64_tr_b16 v[114:115], v16 offset:49664
    ds_read_b128 v[116:119], v18 offset:0
    ds_read_b64_tr_b16 v[80:81], v16 offset:51200
    ds_read_b64_tr_b16 v[82:83], v16 offset:51712
    ds_read_b128 v[84:87], v18 offset:1024
    ds_read_b64_tr_b16 v[88:89], v16 offset:53248
    ds_read_b64_tr_b16 v[90:91], v16 offset:53760
    ds_read_b128 v[92:95], v18 offset:2048
    ds_read_b64_tr_b16 v[96:97], v16 offset:55296
    ds_read_b64_tr_b16 v[98:99], v16 offset:55808
    ds_read_b128 v[100:103], v18 offset:3072
    v_mfma_f32_32x32x16_bf16 v[64:79], v[104:107], v[108:111], v[64:79]
    ds_read_b64_tr_b16 v[104:105], v16 offset:57344
    ds_read_b64_tr_b16 v[106:107], v16 offset:57856
    ds_read_b128 v[108:111], v18 offset:4096
    s_waitcnt lgkmcnt(12)
    v_mfma_f32_32x32x16_bf16 v[64:79], v[112:115], v[116:119], v[64:79]
    ds_read_b64_tr_b16 v[112:113], v16 offset:59392
    ds_read_b64_tr_b16 v[114:115], v16 offset:59904
    ds_read_b128 v[116:119], v18 offset:5120
    s_waitcnt lgkmcnt(12)
    v_mfma_f32_32x32x16_bf16 v[64:79], v[80:83], v[84:87], v[64:79]
    ds_read_b64_tr_b16 v[80:81], v16 offset:61440
    ds_read_b64_tr_b16 v[82:83], v16 offset:61952
    ds_read_b128 v[84:87], v18 offset:6144
    s_waitcnt lgkmcnt(12)
    v_mfma_f32_32x32x16_bf16 v[64:79], v[88:91], v[92:95], v[64:79]
    ds_read_b64_tr_b16 v[88:89], v16 offset:63488
    ds_read_b64_tr_b16 v[90:91], v16 offset:64000
    ds_read_b128 v[92:95], v18 offset:7168
    s_waitcnt lgkmcnt(12)
    v_mfma_f32_32x32x16_bf16 v[64:79], v[96:99], v[100:103], v[64:79]
    s_waitcnt lgkmcnt(9)
    v_mfma_f32_32x32x16_bf16 v[64:79], v[104:107], v[108:111], v[64:79]
    s_waitcnt lgkmcnt(6)
    v_mfma_f32_32x32x16_bf16 v[64:79], v[112:115], v[116:119], v[64:79]
    s_waitcnt lgkmcnt(3)
    v_mfma_f32_32x32x16_bf16 v[64:79], v[80:83], v[84:87], v[64:79]
    s_waitcnt lgkmcnt(0)
    s_barrier
    ds_read_b64_tr_b16 v[96:97], v17 offset:0
    ds_read_b64_tr_b16 v[98:99], v17 offset:512
    ds_read_b128 v[100:103], v18 offset:16384
    ds_read_b64_tr_b16 v[104:105], v17 offset:2048
    ds_read_b64_tr_b16 v[106:107], v17 offset:2560
    ds_read_b128 v[108:111], v18 offset:17408
    ds_read_b64_tr_b16 v[112:113], v17 offset:4096
    ds_read_b64_tr_b16 v[114:115], v17 offset:4608
    ds_read_b128 v[116:119], v18 offset:18432
    ds_read_b64_tr_b16 v[80:81], v17 offset:6144
    ds_read_b64_tr_b16 v[82:83], v17 offset:6656
    ds_read_b128 v[84:87], v18 offset:19456
    v_mfma_f32_32x32x16_bf16 v[64:79], v[88:91], v[92:95], v[64:79]
    ds_read_b64_tr_b16 v[88:89], v17 offset:8192
    ds_read_b64_tr_b16 v[90:91], v17 offset:8704
    ds_read_b128 v[92:95], v18 offset:20480
    s_waitcnt lgkmcnt(12)
    v_mfma_f32_32x32x16_bf16 v[64:79], v[96:99], v[100:103], v[64:79]
    ds_read_b64_tr_b16 v[96:97], v17 offset:10240
    ds_read_b64_tr_b16 v[98:99], v17 offset:10752
    ds_read_b128 v[100:103], v18 offset:21504
    s_waitcnt lgkmcnt(12)
    v_mfma_f32_32x32x16_bf16 v[64:79], v[104:107], v[108:111], v[64:79]
    ds_read_b64_tr_b16 v[104:105], v17 offset:12288
    ds_read_b64_tr_b16 v[106:107], v17 offset:12800
    ds_read_b128 v[108:111], v18 offset:22528
    s_waitcnt lgkmcnt(12)
    v_mfma_f32_32x32x16_bf16 v[64:79], v[112:115], v[116:119], v[64:79]
    ds_read_b64_tr_b16 v[112:113], v17 offset:14336
    ds_read_b64_tr_b16 v[114:115], v17 offset:14848
    ds_read_b128 v[116:119], v18 offset:23552
    s_waitcnt lgkmcnt(12)
    v_mfma_f32_32x32x16_bf16 v[64:79], v[80:83], v[84:87], v[64:79]
    s_waitcnt lgkmcnt(9)
    v_mfma_f32_32x32x16_bf16 v[64:79], v[88:91], v[92:95], v[64:79]
    s_waitcnt lgkmcnt(6)
    v_mfma_f32_32x32x16_bf16 v[64:79], v[96:99], v[100:103], v[64:79]
    s_waitcnt lgkmcnt(3)
    v_mfma_f32_32x32x16_bf16 v[64:79], v[104:107], v[108:111], v[64:79]
    s_waitcnt lgkmcnt(0)
    s_barrier
    ds_read_b64_tr_b16 v[80:81], v17 offset:16384
    ds_read_b64_tr_b16 v[82:83], v17 offset:16896
    ds_read_b128 v[84:87], v18 offset:32768
    ds_read_b64_tr_b16 v[88:89], v17 offset:18432
    ds_read_b64_tr_b16 v[90:91], v17 offset:18944
    ds_read_b128 v[92:95], v18 offset:33792
    ds_read_b64_tr_b16 v[96:97], v17 offset:20480
    ds_read_b64_tr_b16 v[98:99], v17 offset:20992
    ds_read_b128 v[100:103], v18 offset:34816
    ds_read_b64_tr_b16 v[104:105], v17 offset:22528
    ds_read_b64_tr_b16 v[106:107], v17 offset:23040
    ds_read_b128 v[108:111], v18 offset:35840
    v_mfma_f32_32x32x16_bf16 v[64:79], v[112:115], v[116:119], v[64:79]
    ds_read_b64_tr_b16 v[112:113], v17 offset:24576
    ds_read_b64_tr_b16 v[114:115], v17 offset:25088
    ds_read_b128 v[116:119], v18 offset:36864
    s_waitcnt lgkmcnt(12)
    v_mfma_f32_32x32x16_bf16 v[64:79], v[80:83], v[84:87], v[64:79]
    ds_read_b64_tr_b16 v[80:81], v17 offset:26624
    ds_read_b64_tr_b16 v[82:83], v17 offset:27136
    ds_read_b128 v[84:87], v18 offset:37888
    s_waitcnt lgkmcnt(12)
    v_mfma_f32_32x32x16_bf16 v[64:79], v[88:91], v[92:95], v[64:79]
    ds_read_b64_tr_b16 v[88:89], v17 offset:28672
    ds_read_b64_tr_b16 v[90:91], v17 offset:29184
    ds_read_b128 v[92:95], v18 offset:38912
    s_waitcnt lgkmcnt(12)
    v_mfma_f32_32x32x16_bf16 v[64:79], v[96:99], v[100:103], v[64:79]
    ds_read_b64_tr_b16 v[96:97], v17 offset:30720
    ds_read_b64_tr_b16 v[98:99], v17 offset:31232
    ds_read_b128 v[100:103], v18 offset:39936
    s_waitcnt lgkmcnt(12)
    v_mfma_f32_32x32x16_bf16 v[64:79], v[104:107], v[108:111], v[64:79]
    s_waitcnt lgkmcnt(9)
    v_mfma_f32_32x32x16_bf16 v[64:79], v[112:115], v[116:119], v[64:79]
    s_waitcnt lgkmcnt(6)
    v_mfma_f32_32x32x16_bf16 v[64:79], v[80:83], v[84:87], v[64:79]
    s_waitcnt lgkmcnt(3)
    v_mfma_f32_32x32x16_bf16 v[64:79], v[88:91], v[92:95], v[64:79]
    s_waitcnt lgkmcnt(0)
    s_barrier
    ds_read_b64_tr_b16 v[104:105], v16 offset:0
    ds_read_b64_tr_b16 v[106:107], v16 offset:512
    ds_read_b128 v[108:111], v18 offset:0
    ds_read_b64_tr_b16 v[112:113], v16 offset:2048
    ds_read_b64_tr_b16 v[114:115], v16 offset:2560
    ds_read_b128 v[116:119], v18 offset:1024
    ds_read_b64_tr_b16 v[80:81], v16 offset:4096
    ds_read_b64_tr_b16 v[82:83], v16 offset:4608
    ds_read_b128 v[84:87], v18 offset:2048
    ds_read_b64_tr_b16 v[88:89], v16 offset:6144
    ds_read_b64_tr_b16 v[90:91], v16 offset:6656
    ds_read_b128 v[92:95], v18 offset:3072
    v_mfma_f32_32x32x16_bf16 v[64:79], v[96:99], v[100:103], v[64:79]
    ds_read_b64_tr_b16 v[96:97], v16 offset:8192
    ds_read_b64_tr_b16 v[98:99], v16 offset:8704
    ds_read_b128 v[100:103], v18 offset:4096
    s_waitcnt lgkmcnt(12)
    v_mfma_f32_32x32x16_bf16 v[64:79], v[104:107], v[108:111], v[64:79]
    ds_read_b64_tr_b16 v[104:105], v16 offset:10240
    ds_read_b64_tr_b16 v[106:107], v16 offset:10752
    ds_read_b128 v[108:111], v18 offset:5120
    s_waitcnt lgkmcnt(12)
    v_mfma_f32_32x32x16_bf16 v[64:79], v[112:115], v[116:119], v[64:79]
    ds_read_b64_tr_b16 v[112:113], v16 offset:12288
    ds_read_b64_tr_b16 v[114:115], v16 offset:12800
    ds_read_b128 v[116:119], v18 offset:6144
    s_waitcnt lgkmcnt(12)
    v_mfma_f32_32x32x16_bf16 v[64:79], v[80:83], v[84:87], v[64:79]
    ds_read_b64_tr_b16 v[80:81], v16 offset:14336
    ds_read_b64_tr_b16 v[82:83], v16 offset:14848
    ds_read_b128 v[84:87], v18 offset:7168
    s_waitcnt lgkmcnt(12)
    v_mfma_f32_32x32x16_bf16 v[64:79], v[88:91], v[92:95], v[64:79]
    s_waitcnt lgkmcnt(9)
    v_mfma_f32_32x32x16_bf16 v[64:79], v[96:99], v[100:103], v[64:79]
    s_waitcnt lgkmcnt(6)
    v_mfma_f32_32x32x16_bf16 v[64:79], v[104:107], v[108:111], v[64:79]
    s_waitcnt lgkmcnt(3)
    v_mfma_f32_32x32x16_bf16 v[64:79], v[112:115], v[116:119], v[64:79]
    s_waitcnt lgkmcnt(0)
    s_barrier
    ds_read_b64_tr_b16 v[88:89], v16 offset:16384
    ds_read_b64_tr_b16 v[90:91], v16 offset:16896
    ds_read_b128 v[92:95], v18 offset:16384
    ds_read_b64_tr_b16 v[96:97], v16 offset:18432
    ds_read_b64_tr_b16 v[98:99], v16 offset:18944
    ds_read_b128 v[100:103], v18 offset:17408
    ds_read_b64_tr_b16 v[104:105], v16 offset:20480
    ds_read_b64_tr_b16 v[106:107], v16 offset:20992
    ds_read_b128 v[108:111], v18 offset:18432
    ds_read_b64_tr_b16 v[112:113], v16 offset:22528
    ds_read_b64_tr_b16 v[114:115], v16 offset:23040
    ds_read_b128 v[116:119], v18 offset:19456
    v_mfma_f32_32x32x16_bf16 v[64:79], v[80:83], v[84:87], v[64:79]
    ds_read_b64_tr_b16 v[80:81], v16 offset:24576
    ds_read_b64_tr_b16 v[82:83], v16 offset:25088
    ds_read_b128 v[84:87], v18 offset:20480
    s_waitcnt lgkmcnt(12)
    v_mfma_f32_32x32x16_bf16 v[64:79], v[88:91], v[92:95], v[64:79]
    ds_read_b64_tr_b16 v[88:89], v16 offset:26624
    ds_read_b64_tr_b16 v[90:91], v16 offset:27136
    ds_read_b128 v[92:95], v18 offset:21504
    s_waitcnt lgkmcnt(12)
    v_mfma_f32_32x32x16_bf16 v[64:79], v[96:99], v[100:103], v[64:79]
    ds_read_b64_tr_b16 v[96:97], v16 offset:28672
    ds_read_b64_tr_b16 v[98:99], v16 offset:29184
    ds_read_b128 v[100:103], v18 offset:22528
    s_waitcnt lgkmcnt(12)
    v_mfma_f32_32x32x16_bf16 v[64:79], v[104:107], v[108:111], v[64:79]
    ds_read_b64_tr_b16 v[104:105], v16 offset:30720
    ds_read_b64_tr_b16 v[106:107], v16 offset:31232
    ds_read_b128 v[108:111], v18 offset:23552
    s_waitcnt lgkmcnt(12)
    v_mfma_f32_32x32x16_bf16 v[64:79], v[112:115], v[116:119], v[64:79]
    s_waitcnt lgkmcnt(9)
    v_mfma_f32_32x32x16_bf16 v[64:79], v[80:83], v[84:87], v[64:79]
    s_waitcnt lgkmcnt(6)
    v_mfma_f32_32x32x16_bf16 v[64:79], v[88:91], v[92:95], v[64:79]
    s_waitcnt lgkmcnt(3)
    v_mfma_f32_32x32x16_bf16 v[64:79], v[96:99], v[100:103], v[64:79]
    s_waitcnt lgkmcnt(0)
    s_barrier
    ds_read_b64_tr_b16 v[112:113], v16 offset:32768
    ds_read_b64_tr_b16 v[114:115], v16 offset:33280
    ds_read_b128 v[116:119], v18 offset:32768
    ds_read_b64_tr_b16 v[80:81], v16 offset:34816
    ds_read_b64_tr_b16 v[82:83], v16 offset:35328
    ds_read_b128 v[84:87], v18 offset:33792
    ds_read_b64_tr_b16 v[88:89], v16 offset:36864
    ds_read_b64_tr_b16 v[90:91], v16 offset:37376
    ds_read_b128 v[92:95], v18 offset:34816
    ds_read_b64_tr_b16 v[96:97], v16 offset:38912
    ds_read_b64_tr_b16 v[98:99], v16 offset:39424
    ds_read_b128 v[100:103], v18 offset:35840
    v_mfma_f32_32x32x16_bf16 v[64:79], v[104:107], v[108:111], v[64:79]
    ds_read_b64_tr_b16 v[104:105], v16 offset:40960
    ds_read_b64_tr_b16 v[106:107], v16 offset:41472
    ds_read_b128 v[108:111], v18 offset:36864
    s_waitcnt lgkmcnt(12)
    v_mfma_f32_32x32x16_bf16 v[64:79], v[112:115], v[116:119], v[64:79]
    ds_read_b64_tr_b16 v[112:113], v16 offset:43008
    ds_read_b64_tr_b16 v[114:115], v16 offset:43520
    ds_read_b128 v[116:119], v18 offset:37888
    s_waitcnt lgkmcnt(12)
    v_mfma_f32_32x32x16_bf16 v[64:79], v[80:83], v[84:87], v[64:79]
    ds_read_b64_tr_b16 v[80:81], v16 offset:45056
    ds_read_b64_tr_b16 v[82:83], v16 offset:45568
    ds_read_b128 v[84:87], v18 offset:38912
    s_waitcnt lgkmcnt(12)
    v_mfma_f32_32x32x16_bf16 v[64:79], v[88:91], v[92:95], v[64:79]
    ds_read_b64_tr_b16 v[88:89], v16 offset:47104
    ds_read_b64_tr_b16 v[90:91], v16 offset:47616
    ds_read_b128 v[92:95], v18 offset:39936
    s_waitcnt lgkmcnt(12)
    v_mfma_f32_32x32x16_bf16 v[64:79], v[96:99], v[100:103], v[64:79]
    s_waitcnt lgkmcnt(9)
    v_mfma_f32_32x32x16_bf16 v[64:79], v[104:107], v[108:111], v[64:79]
    s_waitcnt lgkmcnt(6)
    v_mfma_f32_32x32x16_bf16 v[64:79], v[112:115], v[116:119], v[64:79]
    s_waitcnt lgkmcnt(3)
    v_mfma_f32_32x32x16_bf16 v[64:79], v[80:83], v[84:87], v[64:79]
    s_waitcnt lgkmcnt(0)
    s_barrier
    ds_read_b64_tr_b16 v[96:97], v16 offset:49152
    ds_read_b64_tr_b16 v[98:99], v16 offset:49664
    ds_read_b128 v[100:103], v18 offset:0
    ds_read_b64_tr_b16 v[104:105], v16 offset:51200
    ds_read_b64_tr_b16 v[106:107], v16 offset:51712
    ds_read_b128 v[108:111], v18 offset:1024
    ds_read_b64_tr_b16 v[112:113], v16 offset:53248
    ds_read_b64_tr_b16 v[114:115], v16 offset:53760
    ds_read_b128 v[116:119], v18 offset:2048
    ds_read_b64_tr_b16 v[80:81], v16 offset:55296
    ds_read_b64_tr_b16 v[82:83], v16 offset:55808
    ds_read_b128 v[84:87], v18 offset:3072
    v_mfma_f32_32x32x16_bf16 v[64:79], v[88:91], v[92:95], v[64:79]
    ds_read_b64_tr_b16 v[88:89], v16 offset:57344
    ds_read_b64_tr_b16 v[90:91], v16 offset:57856
    ds_read_b128 v[92:95], v18 offset:4096
    s_waitcnt lgkmcnt(12)
    v_mfma_f32_32x32x16_bf16 v[64:79], v[96:99], v[100:103], v[64:79]
    ds_read_b64_tr_b16 v[96:97], v16 offset:59392
    ds_read_b64_tr_b16 v[98:99], v16 offset:59904
    ds_read_b128 v[100:103], v18 offset:5120
    s_waitcnt lgkmcnt(12)
    v_mfma_f32_32x32x16_bf16 v[64:79], v[104:107], v[108:111], v[64:79]
    ds_read_b64_tr_b16 v[104:105], v16 offset:61440
    ds_read_b64_tr_b16 v[106:107], v16 offset:61952
    ds_read_b128 v[108:111], v18 offset:6144
    s_waitcnt lgkmcnt(12)
    v_mfma_f32_32x32x16_bf16 v[64:79], v[112:115], v[116:119], v[64:79]
    ds_read_b64_tr_b16 v[112:113], v16 offset:63488
    ds_read_b64_tr_b16 v[114:115], v16 offset:64000
    ds_read_b128 v[116:119], v18 offset:7168
    s_waitcnt lgkmcnt(12)
    v_mfma_f32_32x32x16_bf16 v[64:79], v[80:83], v[84:87], v[64:79]
    s_waitcnt lgkmcnt(9)
    v_mfma_f32_32x32x16_bf16 v[64:79], v[88:91], v[92:95], v[64:79]
    s_waitcnt lgkmcnt(6)
    v_mfma_f32_32x32x16_bf16 v[64:79], v[96:99], v[100:103], v[64:79]
    s_waitcnt lgkmcnt(3)
    v_mfma_f32_32x32x16_bf16 v[64:79], v[104:107], v[108:111], v[64:79]
    s_waitcnt lgkmcnt(0)
    s_barrier
    ds_read_b64_tr_b16 v[80:81], v17 offset:0
    ds_read_b64_tr_b16 v[82:83], v17 offset:512
    ds_read_b128 v[84:87], v18 offset:16384
    ds_read_b64_tr_b16 v[88:89], v17 offset:2048
    ds_read_b64_tr_b16 v[90:91], v17 offset:2560
    ds_read_b128 v[92:95], v18 offset:17408
    ds_read_b64_tr_b16 v[96:97], v17 offset:4096
    ds_read_b64_tr_b16 v[98:99], v17 offset:4608
    ds_read_b128 v[100:103], v18 offset:18432
    ds_read_b64_tr_b16 v[104:105], v17 offset:6144
    ds_read_b64_tr_b16 v[106:107], v17 offset:6656
    ds_read_b128 v[108:111], v18 offset:19456
    v_mfma_f32_32x32x16_bf16 v[64:79], v[112:115], v[116:119], v[64:79]
    ds_read_b64_tr_b16 v[112:113], v17 offset:8192
    ds_read_b64_tr_b16 v[114:115], v17 offset:8704
    ds_read_b128 v[116:119], v18 offset:20480
    s_waitcnt lgkmcnt(12)
    v_mfma_f32_32x32x16_bf16 v[64:79], v[80:83], v[84:87], v[64:79]
    ds_read_b64_tr_b16 v[80:81], v17 offset:10240
    ds_read_b64_tr_b16 v[82:83], v17 offset:10752
    ds_read_b128 v[84:87], v18 offset:21504
    s_waitcnt lgkmcnt(12)
    v_mfma_f32_32x32x16_bf16 v[64:79], v[88:91], v[92:95], v[64:79]
    ds_read_b64_tr_b16 v[88:89], v17 offset:12288
    ds_read_b64_tr_b16 v[90:91], v17 offset:12800
    ds_read_b128 v[92:95], v18 offset:22528
    s_waitcnt lgkmcnt(12)
    v_mfma_f32_32x32x16_bf16 v[64:79], v[96:99], v[100:103], v[64:79]
    ds_read_b64_tr_b16 v[96:97], v17 offset:14336
    ds_read_b64_tr_b16 v[98:99], v17 offset:14848
    ds_read_b128 v[100:103], v18 offset:23552
    s_waitcnt lgkmcnt(12)
    v_mfma_f32_32x32x16_bf16 v[64:79], v[104:107], v[108:111], v[64:79]
    s_waitcnt lgkmcnt(9)
    v_mfma_f32_32x32x16_bf16 v[64:79], v[112:115], v[116:119], v[64:79]
    s_waitcnt lgkmcnt(6)
    v_mfma_f32_32x32x16_bf16 v[64:79], v[80:83], v[84:87], v[64:79]
    s_waitcnt lgkmcnt(3)
    v_mfma_f32_32x32x16_bf16 v[64:79], v[88:91], v[92:95], v[64:79]
    s_waitcnt lgkmcnt(0)
    v_mfma_f32_32x32x16_bf16 v[64:79], v[96:99], v[100:103], v[64:79]
    s_nop 7
    s_nop 3
    v_fma_f32 v48, v64, v32, v48
    v_fma_f32 v49, v65, v33, v49
    v_fma_f32 v50, v66, v34, v50
    v_fma_f32 v51, v67, v35, v51
    v_cvt_pk_bf16_f32 v80, v48, v49
    v_cvt_pk_bf16_f32 v81, v50, v51
    v_fma_f32 v52, v68, v36, v52
    v_fma_f32 v53, v69, v37, v53
    v_fma_f32 v54, v70, v38, v54
    v_fma_f32 v55, v71, v39, v55
    v_cvt_pk_bf16_f32 v82, v52, v53
    v_cvt_pk_bf16_f32 v83, v54, v55
    v_fma_f32 v56, v72, v40, v56
    v_fma_f32 v57, v73, v41, v57
    v_fma_f32 v58, v74, v42, v58
    v_fma_f32 v59, v75, v43, v59
    v_cvt_pk_bf16_f32 v84, v56, v57
    v_cvt_pk_bf16_f32 v85, v58, v59
    v_fma_f32 v60, v76, v44, v60
    v_fma_f32 v61, v77, v45, v61
    v_fma_f32 v62, v78, v46, v62
    v_fma_f32 v63, v79, v47, v63
    v_cvt_pk_bf16_f32 v86, v60, v61
    v_cvt_pk_bf16_f32 v87, v62, v63
    s_nop 1
    v_permlane32_swap_b32 v80, v82
    v_permlane32_swap_b32 v81, v83
    v_permlane32_swap_b32 v84, v86
    v_permlane32_swap_b32 v85, v87
    global_store_dwordx4 v20, v[80:83], s[48:49]
    global_store_dwordx4 v20, v[84:87], s[48:49] offset:32
cd_exit:
    s_endpgm
ab_other:
    s_endpgm
.p2align 4
.type kidx_table,@object
kidx_table:
    .short 12388, 12388, 12388, 12388, 12384, 12384, 12384, 12384, 12384, 12384, 12384, 0
    .short 12384, 12384, 12384, 12380, 12380, 12380, 12380, 12380, 12380, 12380, 12380, 0
    .short 12380, 12380, 12380, 12380, 12376, 12376, 12376, 12376, 12376, 12376, 12376, 0
    .short 12376, 12376, 12376, 12372, 12372, 12372, 12372, 12372, 12372, 12372, 12372, 0
    .short 12372, 12372, 12372, 12372, 12368, 12368, 12368, 12368, 12368, 12368, 12368, 0
    .short 12368, 12368, 12368, 12364, 12364, 12364, 12364, 12364, 12364, 12364, 12364, 0
    .short 12364, 12364, 12364, 12364, 12360, 12360, 12360, 12360, 12360, 12360, 12360, 0
    .short 12360, 12360, 12360, 12356, 12356, 12356, 12356, 12356, 12356, 12356, 12356, 0
    .short 12356, 12356, 12356, 12356, 12352, 12352, 12352, 12352, 12352, 12352, 12352, 0
    .short 12352, 12352, 12352, 12348, 12348, 12348, 12348, 12348, 12348, 12348, 12348, 0
    .short 12348, 12348, 12348, 12348, 12344, 12344, 12344, 12344, 12344, 12344, 12344, 0
    .short 12344, 12344, 12344, 12340, 12340, 12340, 12340, 12340, 12340, 12340, 12340, 0
    .short 12340, 12340, 12340, 12340, 12336, 12336, 12336, 12336, 12336, 12336, 12336, 0
    .short 12336, 12336, 12336, 12332, 12332, 12332, 12332, 12332, 12332, 12332, 12332, 0
    .short 12332, 12332, 12332, 12332, 12328, 12328, 12328, 12328, 12328, 12328, 12328, 0
    .short 12328, 12328, 12328, 12324, 12324, 12324, 12324, 12324, 12324, 12324, 12324, 0
    .short 12324, 12324, 12324, 12324, 12320, 12320, 12320, 12320, 12320, 12320, 12320, 0
    .short 12320, 12320, 12320, 12316, 12316, 12316, 12316, 12316, 12316, 12316, 12316, 0
    .short 12316, 12316, 12316, 12316, 12312, 12312, 12312, 12312, 12312, 12312, 12312, 0
    .short 12312, 12312, 12312, 12308, 12308, 12308, 12308, 12308, 12308, 12308, 12308, 0
    .short 12308, 12308, 12308, 12308, 12304, 12304, 12304, 12304, 12304, 12304, 12304, 0
    .short 12304, 12304, 12304, 12300, 12300, 12300, 12300, 12300, 12300, 12300, 12300, 0
    .short 12300, 12300, 12300, 12300, 12296, 12296, 12296, 12296, 12296, 12296, 12296, 0
    .short 12296, 12296, 12296, 12292, 12292, 12292, 12292, 12292, 12292, 12292, 12292, 0
    .short 12292, 12292, 12292, 12292, 12288, 12288, 12288, 12288, 12288, 12288, 12288, 0
    .short 12288, 12288, 12288, 12284, 12284, 12284, 12284, 12284, 12284, 12284, 12284, 0
    .short 12284, 12284, 12284, 12284, 12280, 12280, 12280, 12280, 12280, 12280, 12280, 0
    .short 12280, 12280, 12280, 12276, 12276, 12276, 12276, 12276, 12276, 12276, 12276, 0
    .short 12276, 12276, 12276, 12276, 12272, 12272, 12272, 12272, 12272, 12272, 12272, 0
    .short 12272, 12272, 12272, 12268, 12268, 12268, 12268, 12268, 12268, 12268, 12268, 0
    .short 12268, 12268, 12268, 12268, 12264, 12264, 12264, 12264, 12264, 12264, 12264, 0
    .short 12264, 12264, 12264, 12260, 12260, 12260, 12260, 12260, 12260, 12260, 12260, 0
    .short 12260, 12260, 12260, 12260, 12256, 12256, 12256, 12256, 12256, 12256, 12256, 0
    .short 12256, 12256, 12256, 12252, 12252, 12252, 12252, 12252, 12252, 12252, 12252, 0
    .short 12252, 12252, 12252, 12252, 12248, 12248, 12248, 12248, 12248, 12248, 12248, 0
    .short 12248, 12248, 12248, 12244, 12244, 12244, 12244, 12244, 12244, 12244, 12244, 0
    .short 12244, 12244, 12244, 12244, 12240, 12240, 12240, 12240, 12240, 12240, 12240, 0
    .short 12240, 12240, 12240, 12236, 12236, 12236, 12236, 12236, 12236, 12236, 12236, 0
    .short 12236, 12236, 12236, 12236, 12232, 12232, 12232, 12232, 12232, 12232, 12232, 0
    .short 12232, 12232, 12232, 12228, 12228, 12228, 12228, 12228, 12228, 12228, 12228, 0
    .short 12228, 12228, 12228, 12228, 12224, 12224, 12224, 12224, 12224, 12224, 12224, 0
    .short 12224, 12224, 12224, 12220, 12220, 12220, 12220, 12220, 12220, 12220, 12220, 0
    .short 12220, 12220, 12220, 12220, 12216, 12216, 12216, 12216, 12216, 12216, 12216, 0
    .short 12216, 12216, 12216, 12212, 12212, 12212, 12212, 12212, 12212, 12212, 12212, 0
    .short 12212, 12212, 12212, 12212, 12208, 12208, 12208, 12208, 12208, 12208, 12208, 0
    .short 12208, 12208, 12208, 12204, 12204, 12204, 12204, 12204, 12204, 12204, 12204, 0
    .short 12204, 12204, 12204, 12204, 12200, 12200, 12200, 12200, 12200, 12200, 12200, 0
    .short 12200, 12200, 12200, 12196, 12196, 12196, 12196, 12196, 12196, 12196, 12196, 0
    .short 12196, 12196, 12196, 12196, 12192, 12192, 12192, 12192, 12192, 12192, 12192, 0
    .short 12192, 12192, 12192, 12188, 12188, 12188, 12188, 12188, 12188, 12188, 12188, 0
    .short 12188, 12188, 12188, 12188, 12184, 12184, 12184, 12184, 12184, 12184, 12184, 0
    .short 12184, 12184, 12184, 12180, 12180, 12180, 12180, 12180, 12180, 12180, 12180, 0
    .short 12180, 12180, 12180, 12180, 12176, 12176, 12176, 12176, 12176, 12176, 12176, 0
    .short 12176, 12176, 12176, 12172, 12172, 12172, 12172, 12172, 12172, 12172, 12172, 0
    .short 12172, 12172, 12172, 12172, 12168, 12168, 12168, 12168, 12168, 12168, 12168, 0
    .short 12168, 12168, 12168, 12164, 12164, 12164, 12164, 12164, 12164, 12164, 12164, 0
    .short 12164, 12164, 12164, 12164, 12160, 12160, 12160, 12160, 12160, 12160, 12160, 0
    .short 12160, 12160, 12160, 12156, 12156, 12156, 12156, 12156, 12156, 12156, 12156, 0
    .short 12156, 12156, 12156, 12156, 12152, 12152, 12152, 12152, 12152, 12152, 12152, 0
    .short 12152, 12152, 12152, 12148, 12148, 12148, 12148, 12148, 12148, 12148, 12148, 0
    .short 12148, 12148, 12148, 12148, 12144, 12144, 12144, 12144, 12144, 12144, 12144, 0
    .short 12144, 12144, 12144, 12140, 12140, 12140, 12140, 12140, 12140, 12140, 12140, 0
    .short 12140, 12140, 12140, 12140, 12136, 12136, 12136, 12136, 12136, 12136, 12136, 0
    .short 12136, 12136, 12136, 12132, 12132, 12132, 12132, 12132, 12132, 12132, 12132, 0
    .short 12132, 12132, 12132, 12132, 12128, 12128, 12128, 12128, 12128, 12128, 12128, 0
    .short 12128, 12128, 12128, 12124, 12124, 12124, 12124, 12124, 12124, 12124, 12124, 0
    .short 12124, 12124, 12124, 12124, 12120, 12120, 12120, 12120, 12120, 12120, 12120, 0
    .short 12120, 12120, 12120, 12116, 12116, 12116, 12116, 12116, 12116, 12116, 12116, 0
    .short 12116, 12116, 12116, 12116, 12112, 12112, 12112, 12112, 12112, 12112, 12112, 0
    .short 12112, 12112, 12112, 12108, 12108, 12108, 12108, 12108, 12108, 12108, 12108, 0
    .short 12108, 12108, 12108, 12108, 12104, 12104, 12104, 12104, 12104, 12104, 12104, 0
    .short 12104, 12104, 12104, 12100, 12100, 12100, 12100, 12100, 12100, 12100, 12100, 0
    .short 12100, 12100, 12100, 12100, 12096, 12096, 12096, 12096, 12096, 12096, 12096, 0
    .short 12096, 12096, 12096, 12092, 12092, 12092, 12092, 12092, 12092, 12092, 12092, 0
    .short 12092, 12092, 12092, 12092, 12088, 12088, 12088, 12088, 12088, 12088, 12088, 0
    .short 12088, 12088, 12088, 12084, 12084, 12084, 12084, 12084, 12084, 12084, 12084, 0
    .short 12084, 12084, 12084, 12084, 12080, 12080, 12080, 12080, 12080, 12080, 12080, 0
    .short 12080, 12080, 12080, 12076, 12076, 12076, 12076, 12076, 12076, 12076, 12076, 0
    .short 12076, 12076, 12076, 12076, 12072, 12072, 12072, 12072, 12072, 12072, 12072, 0
    .short 12072, 12072, 12072, 12068, 12068, 12068, 12068, 12068, 12068, 12068, 12068, 0
    .short 12068, 12068, 12068, 12068, 12064, 12064, 12064, 12064, 12064, 12064, 12064, 0
    .short 12064, 12064, 12064, 12060, 12060, 12060, 12060, 12060, 12060, 12060, 12060, 0
    .short 12060, 12060, 12060, 12060, 12056, 12056, 12056, 12056, 12056, 12056, 12056, 0
    .short 12056, 12056, 12056, 12052, 12052, 12052, 12052, 12052, 12052, 12052, 12052, 0
    .short 12052, 12052, 12052, 12052, 12048, 12048, 12048, 12048, 12048, 12048, 12048, 0
    .short 12048, 12048, 12048, 12044, 12044, 12044, 12044, 12044, 12044, 12044, 12044, 0
    .short 12044, 12044, 12044, 12044, 12040, 12040, 12040, 12040, 12040, 12040, 12040, 0
    .short 12040, 12040, 12040, 12036, 12036, 12036, 12036, 12036, 12036, 12036, 12036, 0
    .short 12036, 12036, 12036, 12036, 12032, 12032, 12032, 12032, 12032, 12032, 12032, 0
    .short 12032, 12032, 12032, 12028, 12028, 12028, 12028, 12028, 12028, 12028, 12028, 0
    .short 12028, 12028, 12028, 12028, 12024, 12024, 12024, 12024, 12024, 12024, 12024, 0
    .short 12024, 12024, 12024, 12020, 12020, 12020, 12020, 12020, 12020, 12020, 12020, 0
    .short 12020, 12020, 12020, 12020, 12016, 12016, 12016, 12016, 12016, 12016, 12016, 0
    .short 12016, 12016, 12016, 12012, 12012, 12012, 12012, 12012, 12012, 12012, 12012, 0
    .short 12012, 12012, 12012, 12012, 12008, 12008, 12008, 12008, 12008, 12008, 12008, 0
    .short 12008, 12008, 12008, 12004, 12004, 12004, 12004, 12004, 12004, 12004, 12004, 0
    .short 12004, 12004, 12004, 12004, 12000, 12000, 12000, 12000, 12000, 12000, 12000, 0
    .short 12000, 12000, 12000, 11996, 11996, 11996, 11996, 11996, 11996, 11996, 11996, 0
    .short 11996, 11996, 11996, 11996, 11992, 11992, 11992, 11992, 11992, 11992, 11992, 0
    .short 11992, 11992, 11992, 11988, 11988, 11988, 11988, 11988, 11988, 11988, 11988, 0
    .short 11988, 11988, 11988, 11988, 11984, 11984, 11984, 11984, 11984, 11984, 11984, 0
    .short 11984, 11984, 11984, 11980, 11980, 11980, 11980, 11980, 11980, 11980, 11980, 0
    .short 11980, 11980, 11980, 11980, 11976, 11976, 11976, 11976, 11976, 11976, 11976, 0
    .short 11976, 11976, 11976, 11972, 11972, 11972, 11972, 11972, 11972, 11972, 11972, 0
    .short 11972, 11972, 11972, 11972, 11968, 11968, 11968, 11968, 11968, 11968, 11968, 0
    .short 11968, 11968, 11968, 11964, 11964, 11964, 11964, 11964, 11964, 11964, 11964, 0
    .short 11964, 11964, 11964, 11964, 11960, 11960, 11960, 11960, 11960, 11960, 11960, 0
    .short 11960, 11960, 11960, 11956, 11956, 11956, 11956, 11956, 11956, 11956, 11956, 0
    .short 11956, 11956, 11956, 11956, 11952, 11952, 11952, 11952, 11952, 11952, 11952, 0
    .short 11952, 11952, 11952, 11948, 11948, 11948, 11948, 11948, 11948, 11948, 11948, 0
    .short 11948, 11948, 11948, 11948, 11944, 11944, 11944, 11944, 11944, 11944, 11944, 0
    .short 11944, 11944, 11944, 11940, 11940, 11940, 11940, 11940, 11940, 11940, 11940, 0
    .short 11940, 11940, 11940, 11940, 11936, 11936, 11936, 11936, 11936, 11936, 11936, 0
    .short 11936, 11936, 11936, 11932, 11932, 11932, 11932, 11932, 11932, 11932, 11932, 0
    .short 11932, 11932, 11932, 11932, 11928, 11928, 11928, 11928, 11928, 11928, 11928, 0
    .short 11928, 11928, 11928, 11924, 11924, 11924, 11924, 11924, 11924, 11924, 11924, 0
    .short 11924, 11924, 11924, 11924, 11920, 11920, 11920, 11920, 11920, 11920, 11920, 0
    .short 11920, 11920, 11920, 11916, 11916, 11916, 11916, 11916, 11916, 11916, 11916, 0
    .short 11916, 11916, 11916, 11916, 11912, 11912, 11912, 11912, 11912, 11912, 11912, 0
    .short 11912, 11912, 11912, 11908, 11908, 11908, 11908, 11908, 11908, 11908, 11908, 0
    .short 11908, 11908, 11908, 11908, 11904, 11904, 11904, 11904, 11904, 11904, 11904, 0
    .short 11904, 11904, 11904, 11900, 11900, 11900, 11900, 11900, 11900, 11900, 11900, 0
    .short 11900, 11900, 11900, 11900, 11896, 11896, 11896, 11896, 11896, 11896, 11896, 0
    .short 11896, 11896, 11896, 11892, 11892, 11892, 11892, 11892, 11892, 11892, 11892, 0
    .short 11892, 11892, 11892, 11892, 11888, 11888, 11888, 11888, 11888, 11888, 11888, 0
    .short 11888, 11888, 11888, 11884, 11884, 11884, 11884, 11884, 11884, 11884, 11884, 0
    .short 11884, 11884, 11884, 11884, 11880, 11880, 11880, 11880, 11880, 11880, 11880, 0
    .short 11880, 11880, 11880, 11876, 11876, 11876, 11876, 11876, 11876, 11876, 11872, 0
    .short 11876, 11876, 11872, 11872, 11872, 11868, 11868, 11868, 11868, 11868, 11864, 0
    .short 11868, 11868, 11864, 11864, 11864, 11860, 11860, 11860, 11860, 11860, 11856, 0
    .short 11860, 11860, 11856, 11856, 11856, 11852, 11852, 11852, 11852, 11852, 11848, 0
    .short 11852, 11852, 11848, 11848, 11848, 11844, 11844, 11844, 11844, 11844, 11840, 0
    .short 11844, 11844, 11840, 11840, 11840, 11836, 11836, 11836, 11836, 11836, 11832, 0
    .short 11836, 11836, 11832, 11832, 11832, 11828, 11828, 11828, 11828, 11828, 11824, 0
    .short 11828, 11828, 11824, 11824, 11824, 11820, 11820, 11820, 11820, 11820, 11816, 0
    .short 11820, 11820, 11816, 11816, 11816, 11812, 11812, 11812, 11812, 11812, 11808, 0
    .short 11812, 11812, 11808, 11808, 11808, 11804, 11804, 11804, 11804, 11804, 11800, 0
    .short 11804, 11804, 11800, 11800, 11800, 11796, 11796, 11796, 11796, 11796, 11792, 0
    .short 11796, 11796, 11792, 11792, 11792, 11788, 11788, 11788, 11788, 11788, 11784, 0
    .short 11788, 11788, 11784, 11784, 11784, 11780, 11780, 11780, 11780, 11780, 11776, 0
    .short 11780, 11780, 11776, 11776, 11776, 11772, 11772, 11772, 11772, 11772, 11768, 0
    .short 11772, 11772, 11768, 11768, 11768, 11764, 11764, 11764, 11764, 11764, 11760, 0
    .short 11764, 11764, 11760, 11760, 11760, 11756, 11756, 11756, 11756, 11756, 11752, 0
    .short 11756, 11756, 11752, 11752, 11752, 11748, 11748, 11748, 11748, 11748, 11744, 0
    .short 11748, 11748, 11744, 11744, 11744, 11740, 11740, 11740, 11740, 11740, 11736, 0
    .short 11740, 11740, 11736, 11736, 11736, 11732, 11732, 11732, 11732, 11732, 11728, 0
    .short 11732, 11732, 11728, 11728, 11728, 11724, 11724, 11724, 11724, 11724, 11720, 0
    .short 11724, 11724, 11720, 11720, 11720, 11716, 11716, 11716, 11716, 11716, 11712, 0
    .short 11716, 11716, 11712, 11712, 11712, 11708, 11708, 11708, 11708, 11708, 11704, 0
    .short 11708, 11708, 11704, 11704, 11704, 11700, 11700, 11700, 11700, 11700, 11696, 0
    .short 11700, 11700, 11696, 11696, 11696, 11692, 11692, 11692, 11692, 11692, 11688, 0
    .short 11692, 11692, 11688, 11688, 11688, 11684, 11684, 11684, 11684, 11684, 11680, 0
    .short 11684, 11684, 11680, 11680, 11680, 11676, 11676, 11676, 11676, 11676, 11672, 0
    .short 11676, 11676, 11672, 11672, 11672, 11668, 11668, 11668, 11668, 11668, 11664, 0
    .short 11668, 11668, 11664, 11664, 11664, 11660, 11660, 11660, 11660, 11660, 11656, 0
    .short 11660, 11660, 11656, 11656, 11656, 11652, 11652, 11652, 11652, 11652, 11648, 0
    .short 11652, 11652, 11648, 11648, 11648, 11644, 11644, 11644, 11644, 11644, 11640, 0
    .short 11644, 11644, 11640, 11640, 11640, 11636, 11636, 11636, 11636, 11636, 11632, 0
    .short 11636, 11636, 11632, 11632, 11632, 11628, 11628, 11628, 11628, 11628, 11624, 0
    .short 11628, 11628, 11624, 11624, 11624, 11620, 11620, 11620, 11620, 11620, 11616, 0
    .short 11620, 11620, 11616, 11616, 11616, 11612, 11612, 11612, 11612, 11612, 11608, 0
    .short 11612, 11612, 11608, 11608, 11608, 11604, 11604, 11604, 11604, 11604, 11600, 0
    .short 11604, 11604, 11600, 11600, 11600, 11596, 11596, 11596, 11596, 11596, 11592, 0
    .short 11596, 11596, 11592, 11592, 11592, 11588, 11588, 11588, 11588, 11588, 11584, 0
    .short 11588, 11588, 11584, 11584, 11584, 11580, 11580, 11580, 11580, 11580, 11576, 0
    .short 11580, 11580, 11576, 11576, 11576, 11572, 11572, 11572, 11572, 11572, 11568, 0
    .short 11572, 11572, 11568, 11568, 11568, 11564, 11564, 11564, 11564, 11564, 11560, 0
    .short 11564, 11564, 11560, 11560, 11560, 11556, 11556, 11556, 11556, 11556, 11552, 0
    .short 11556, 11556, 11552, 11552, 11552, 11548, 11548, 11548, 11548, 11548, 11544, 0
    .short 11548, 11548, 11544, 11544, 11544, 11540, 11540, 11540, 11540, 11540, 11536, 0
    .short 11540, 11540, 11536, 11536, 11536, 11532, 11532, 11532, 11532, 11532, 11528, 0
    .short 11532, 11532, 11528, 11528, 11528, 11524, 11524, 11524, 11524, 11524, 11520, 0
    .short 11524, 11524, 11520, 11520, 11520, 11516, 11516, 11516, 11516, 11516, 11512, 0
    .short 11516, 11516, 11512, 11512, 11512, 11508, 11508, 11508, 11508, 11508, 11504, 0
    .short 11508, 11508, 11504, 11504, 11504, 11500, 11500, 11500, 11500, 11500, 11496, 0
    .short 11500, 11500, 11496, 11496, 11496, 11492, 11492, 11492, 11492, 11492, 11488, 0
    .short 11492, 11492, 11488, 11488, 11488, 11484, 11484, 11484, 11484, 11484, 11480, 0
    .short 11484, 11484, 11480, 11480, 11480, 11476, 11476, 11476, 11476, 11476, 11472, 0
    .short 11476, 11476, 11472, 11472, 11472, 11468, 11468, 11468, 11468, 11468, 11464, 0
    .short 11468, 11468, 11464, 11464, 11464, 11460, 11460, 11460, 11460, 11460, 11456, 0
    .short 11460, 11460, 11456, 11456, 11456, 11452, 11452, 11452, 11452, 11452, 11448, 0
    .short 11452, 11452, 11448, 11448, 11448, 11444, 11444, 11444, 11444, 11444, 11440, 0
    .short 11444, 11444, 11440, 11440, 11440, 11436, 11436, 11436, 11436, 11436, 11432, 0
    .short 11436, 11436, 11432, 11432, 11432, 11428, 11428, 11428, 11428, 11428, 11424, 0
    .short 11428, 11428, 11424, 11424, 11424, 11420, 11420, 11420, 11420, 11420, 11416, 0
    .short 11420, 11420, 11416, 11416, 11416, 11412, 11412, 11412, 11412, 11412, 11408, 0
    .short 11412, 11412, 11408, 11408, 11408, 11404, 11404, 11404, 11404, 11404, 11400, 0
    .short 11404, 11404, 11400, 11400, 11400, 11396, 11396, 11396, 11396, 11396, 11392, 0
    .short 11396, 11396, 11392, 11392, 11392, 11388, 11388, 11388, 11388, 11388, 11384, 0
    .short 11388, 11388, 11384, 11384, 11384, 11380, 11380, 11380, 11380, 11380, 11376, 0
    .short 11380, 11380, 11376, 11376, 11376, 11372, 11372, 11372, 11372, 11372, 11368, 0
    .short 11372, 11372, 11368, 11368, 11368, 11364, 11364, 11364, 11364, 11360, 11356, 0
    .short 11364, 11360, 11356, 11356, 11356, 11352, 11348, 11348, 11348, 11344, 11340, 0
    .short 11348, 11344, 11340, 11340, 11340, 11336, 11332, 11332, 11332, 11328, 11324, 0
    .short 11332, 11328, 11324, 11324, 11324, 11320, 11316, 11316, 11316, 11312, 11308, 0
    .short 11316, 11312, 11308, 11308, 11308, 11304, 11300, 11300, 11300, 11296, 11292, 0
    .short 11300, 11296, 11292, 11292, 11292, 11288, 11284, 11284, 11284, 11280, 11276, 0
    .short 11284, 11280, 11276, 11276, 11276, 11272, 11268, 11268, 11268, 11264, 11260, 0
    .short 11268, 11264, 11260, 11260, 11260, 11256, 11252, 11252, 11252, 11248, 11244, 0
    .short 11252, 11248, 11244, 11244, 11244, 11240, 11236, 11236, 11236, 11232, 11228, 0
    .short 11236, 11232, 11228, 11228, 11228, 11224, 11220, 11220, 11220, 11216, 11212, 0
    .short 11220, 11216, 11212, 11212, 11212, 11208, 11204, 11204, 11204, 11200, 11196, 0
    .short 11204, 11200, 11196, 11196, 11196, 11192, 11188, 11188, 11188, 11184, 11180, 0
    .short 11188, 11184, 11180, 11180, 11180, 11176, 11172, 11172, 11172, 11168, 11164, 0
    .short 11172, 11168, 11164, 11164, 11164, 11160, 11156, 11156, 11156, 11152, 11148, 0
    .short 11156, 11152, 11148, 11148, 11148, 11144, 11140, 11140, 11140, 11136, 11132, 0
    .short 11140, 11136, 11132, 11132, 11132, 11128, 11124, 11124, 11124, 11120, 11116, 0
    .short 11124, 11120, 11116, 11116, 11116, 11112, 11108, 11108, 11108, 11104, 11100, 0
    .short 11108, 11104, 11100, 11100, 11100, 11096, 11092, 11092, 11092, 11088, 11084, 0
    .short 11092, 11088, 11084, 11084, 11084, 11080, 11076, 11076, 11076, 11072, 11068, 0
    .short 11076, 11072, 11068, 11068, 11068, 11064, 11060, 11060, 11060, 11056, 11052, 0
    .short 11060, 11056, 11052, 11052, 11052, 11048, 11044, 11044, 11044, 11040, 11036, 0
    .short 11044, 11040, 11036, 11036, 11036, 11032, 11028, 11028, 11028, 11024, 11020, 0
    .short 11028, 11024, 11020, 11020, 11020, 11016, 11012, 11012, 11012, 11008, 11004, 0
    .short 11012, 11008, 11004, 11004, 11004, 11000, 10996, 10996, 10996, 10992, 10988, 0
    .short 10996, 10992, 10988, 10988, 10988, 10984, 10980, 10980, 10980, 10976, 10972, 0
    .short 10980, 10976, 10972, 10972, 10972, 10968, 10964, 10964, 10964, 10960, 10956, 0
    .short 10964, 10960, 10956, 10956, 10956, 10952, 10948, 10948, 10948, 10944, 10940, 0
    .short 10948, 10944, 10940, 10940, 10940, 10936, 10932, 10932, 10932, 10928, 10924, 0
    .short 10932, 10928, 10924, 10924, 10924, 10920, 10916, 10916, 10916, 10912, 10908, 0
    .short 10916, 10912, 10908, 10908, 10908, 10904, 10900, 10900, 10900, 10896, 10892, 0
    .short 10900, 10896, 10892, 10892, 10892, 10888, 10884, 10884, 10884, 10880, 10876, 0
    .short 10884, 10880, 10876, 10876, 10876, 10872, 10868, 10868, 10868, 10864, 10860, 0
    .short 10868, 10864, 10860, 10860, 10860, 10856, 10852, 10852, 10848, 10844, 10840, 0
    .short 10848, 10844, 10840, 10836, 10832, 10828, 10824, 10820, 10816, 10812, 10808, 0
    .short 10816, 10812, 10808, 10804, 10800, 10796, 10792, 10788, 10784, 10780, 10776, 0
    .short 10784, 10780, 10776, 10772, 10768, 10764, 10760, 10756, 10752, 10748, 10744, 0
    .short 10752, 10748, 10744, 10740, 10736, 10732, 10728, 10724, 10720, 10716, 10712, 0
    .short 10720, 10716, 10712, 10708, 10704, 10700, 10696, 10692, 10688, 10684, 10680, 0
    .short 10688, 10684, 10680, 10676, 10672, 10668, 10664, 10660, 10656, 10652, 10648, 0
    .short 10656, 10652, 10648, 10644, 10640, 10636, 10632, 10628, 10624, 10620, 10616, 0
    .short 10624, 10620, 10616, 10612, 10608, 10604, 10600, 10596, 10592, 10588, 10584, 0
    .short 10592, 10588, 10584, 10580, 10576, 10572, 10568, 10564, 10560, 10556, 10552, 0
    .short 10560, 10556, 10552, 10548, 10544, 10540, 10536, 10532, 10528, 10524, 10520, 0
    .short 10528, 10524, 10520, 10516, 10512, 10508, 10504, 10500, 10496, 10492, 10488, 0
    .short 10496, 10492, 10488, 10484, 10480, 10476, 10472, 10468, 10464, 10460, 10456, 0
    .short 10464, 10460, 10456, 10452, 10448, 10444, 10440, 10436, 10432, 10428, 10424, 0
    .short 10432, 10428, 10424, 10420, 10416, 10412, 10408, 10404, 10400, 10396, 10392, 0
    .short 10400, 10396, 10392, 10388, 10384, 10380, 10376, 10372, 10368, 10364, 10360, 0
    .short 10368, 10364, 10360, 10356, 10352, 10348, 10344, 10340, 10336, 10332, 10328, 0
    .short 10336, 10332, 10328, 10324, 10320, 10316, 10312, 10308, 10304, 10300, 10296, 0
    .short 10304, 10300, 10296, 10292, 10288, 10284, 10280, 10276, 10272, 10268, 10264, 0
    .short 10272, 10268, 10264, 10260, 10256, 10252, 10248, 10244, 10240, 10236, 10232, 0
    .short 10240, 10236, 10232, 10228, 10224, 10220, 10216, 10212, 10208, 10204, 10200, 0
    .short 10208, 10204, 10200, 10196, 10192, 10188, 10184, 10180, 10176, 10172, 10168, 0
    .short 10176, 10172, 10168, 10164, 10160, 10156, 10152, 10148, 10144, 10140, 10136, 0
    .short 10144, 10140, 10136, 10132, 10128, 10124, 10120, 10116, 10112, 10108, 10104, 0
    .short 10112, 10108, 10104, 10100, 10096, 10092, 10088, 10084, 10080, 10076, 10072, 0
    .short 10080, 10076, 10072, 10068, 10064, 10060, 10056, 10052, 10048, 10044, 10040, 0
    .short 10048, 10044, 10040, 10036, 10032, 10028, 10024, 10020, 10016, 10012, 10008, 0
    .short 10016, 10012, 10008, 10004, 10000, 9996, 9992, 9988, 9984, 9980, 9976, 0
    .short 9984, 9980, 9976, 9972, 9968, 9964, 9960, 9956, 9952, 9948, 9944, 0
    .short 9952, 9948, 9944, 9940, 9936, 9932, 9928, 9924, 9920, 9916, 9912, 0
    .short 9920, 9916, 9912, 9908, 9904, 9900, 9896, 9892, 9888, 9884, 9880, 0
    .short 9888, 9884, 9880, 9876, 9872, 9868, 9864, 9860, 9856, 9852, 9848, 0
    .short 9856, 9852, 9848, 9844, 9840, 9836, 9832, 9828, 12900, 12900, 12900, 0
.size kidx_table, 6144

.p2align 8
text_end:
    s_endpgm
.section .rodata,"a"
.p2align 6
.amdhsa_kernel adaLN_cond__ssm_conv_s4__dense_activation_squared_relu__prompt_kernel
  .amdhsa_next_free_vgpr 176
  .amdhsa_next_free_sgpr 96
  .amdhsa_accum_offset 176
  .amdhsa_group_segment_fixed_size 0
  .amdhsa_kernarg_size 152
  .amdhsa_user_sgpr_count 2
  .amdhsa_user_sgpr_kernarg_segment_ptr 1
  .amdhsa_system_sgpr_workgroup_id_x 1
  .amdhsa_float_denorm_mode_32 3
.end_amdhsa_kernel
```
